```python
import torch

def _softmax(x, axis=-1):
    return torch.softmax(x, dim=axis)
def _gelu(x):
    return torch.nn.functional.gelu(x, approximate="tanh")
def _silu(x):
    return torch.nn.functional.silu(x)
def _sigmoid(x):
    return torch.sigmoid(x)
def _layernorm(x, axis=-1, eps=1e-5):
    m = x.mean(dim=axis, keepdim=True)
    v = x.var(dim=axis, keepdim=True, unbiased=False)
    return (x - m) / torch.sqrt(v + eps)
def _scatter_add(tgt, idx, src, axis=0):
    return tgt.clone().index_add_(axis, idx, src)
def _segment_sum(src, seg, n):
    out = torch.zeros((n,) + src.shape[1:], dtype=src.dtype)
    return out.index_add_(0, seg, src)
def _pad(x, pw):
    flat = tuple(v for pair in reversed(pw) for v in pair)
    return torch.nn.functional.pad(x, flat)

kernel_name = 'recurrent_scan__mha_block_cached__glu_gated_swiglu__decode'

def setup_inputs():

    _w = (lambda a: (lambda t: t.to(torch.bfloat16) if t.is_floating_point() else t)(torch.as_tensor(a)))
    def _A_setup():
        B, Sq, D = 1, 1, 640
        H, Sk, Dh = 32, 32768, 192
        return {
            "x": _w((lambda *s: torch.randn(*s, dtype=torch.bfloat16) * 0.2)(B, Sq, D)),
            "k_cache": _w((lambda *s: torch.randn(*s, dtype=torch.bfloat16) * 1.6)(B, H, Sk, Dh)),
            "v_cache": _w((lambda *s: torch.randn(*s, dtype=torch.bfloat16) * 1.6)(B, H, Sk, Dh)),
            "wq": _w((lambda *s: torch.randn(*s, dtype=torch.bfloat16) * 1.6)(D, H * Dh) * (D ** -0.5)),
            "wo": _w((lambda *s: torch.randn(*s, dtype=torch.bfloat16) * 1.6)(H * Dh, D) * ((H * Dh) ** -0.5)),
        }
    _A_in = _A_setup()

    def _B_setup():
        B, S, D, F = 1, 1, 640, 1536
        return {
            "x": _w((lambda *s: torch.randn(*s, dtype=torch.bfloat16) * 0.2)(B, S, D)),
            "w1": _w((lambda *s: torch.randn(*s, dtype=torch.bfloat16) * 0.8)(D, F) * (2.0 / D) ** 0.5),
            "w3": _w((lambda *s: torch.randn(*s, dtype=torch.bfloat16) * 0.8)(D, F) * (2.0 / D) ** 0.5),
            "w2": _w((lambda *s: torch.randn(*s, dtype=torch.bfloat16) * 0.8)(F, D) * (2.0 / F) ** 0.5),
        }
    _B_in = _B_setup()

    return {
        "A_x": _A_in["x"],
        "A_k_cache": _A_in["k_cache"],
        "A_v_cache": _A_in["v_cache"],
        "A_wq": _A_in["wq"],
        "A_wo": _A_in["wo"],
        "B_x": _B_in["x"],
        "B_w1": _B_in["w1"],
        "B_w3": _B_in["w3"],
        "B_w2": _B_in["w2"],
    }

def reference(A_x, A_k_cache, A_v_cache, A_wq, A_wo, B_x, B_w1, B_w3, B_w2):
    def _A_ref(x, k_cache, v_cache, wq, wo):
        B, Sq, D = x.shape
        H, Dh = 32, 192
        q = (lambda x, *d: x.permute(*d))((x @ wq).reshape(B, Sq, H, Dh), 0, 2, 1, 3)
        scores = torch.einsum("bhqd,bhkd->bhqk", q, k_cache) * (Dh ** -0.5)
        p = _softmax(scores, axis=-1)
        o = torch.einsum("bhqk,bhkd->bhqd", p, v_cache)
        return (lambda x, *d: x.permute(*d))(o, 0, 2, 1, 3).reshape(B, Sq, H * Dh) @ wo

    def _B_ref(x, w1, w3, w2):
        gate = torch.einsum("bsd,df->bsf", x, w1)
        up = torch.einsum("bsd,df->bsf", x, w3)
        h = _silu(gate) * up
        out = torch.einsum("bsf,fd->bsd", h, w2)
        return out

    x = A_x
    xn = _layernorm(x, axis=-1)
    s = _A_ref(xn, A_k_cache, A_v_cache, A_wq, A_wo)
    g = _silu(_B_ref(xn, B_w1, B_w3, B_w2))
    return x + s * g
```

```asm
; @launch kernel=proj1_kernel grid=(144,1,1) block=(256,1,1) lds=10752
; @launch kernel=attn_kernel grid=(512,1,1) block=(256,1,1) lds=25088
; @launch kernel=comb_kernel grid=(160,1,1) block=(256,1,1) lds=9728
; @launch kernel=final_kernel grid=(10,1,1) block=(256,1,1) lds=2048
.amdgcn_target "amdgcn-amd-amdhsa--gfx950"
.text
.globl proj1_kernel
.p2align 8
.type proj1_kernel,@function
proj1_kernel:
    s_cmp_ge_u32 s2, 144
    s_cbranch_scc1 L_p1_end
    s_load_dwordx2 s[4:5], s[0:1], 0
    s_load_dwordx2 s[6:7], s[0:1], 24
    s_load_dwordx2 s[8:9], s[0:1], 48
    s_load_dwordx2 s[10:11], s[0:1], 56
    s_load_dwordx2 s[12:13], s[0:1], 88
    s_waitcnt lgkmcnt(0)
    s_cmp_lt_u32 s2, 96
    s_cbranch_scc0 L_p1_b
    s_mov_b32 s14, s6
    s_mov_b32 s15, s7
    s_mov_b32 s16, 12288
    s_mov_b32 s17, 7864320
    s_mul_i32 s19, s2, 43691
    s_lshr_b32 s19, s19, 19
    s_mul_i32 s18, s19, 12
    s_sub_u32 s18, s2, s18
    s_mul_i32 s20, s19, 24576
    s_add_u32 s20, s20, 0
    s_branch L_p1_dec
L_p1_b:
    s_sub_u32 s21, s2, 96
    s_mov_b32 s14, s8
    s_mov_b32 s15, s9
    s_mov_b32 s20, 196608
    s_cmp_lt_u32 s21, 24
    s_cbranch_scc1 L_p1_c
    s_sub_u32 s21, s21, 24
    s_mov_b32 s14, s10
    s_mov_b32 s15, s11
    s_mov_b32 s20, 245760
L_p1_c:
    s_mov_b32 s16, 3072
    s_mov_b32 s17, 1966080
    s_mul_i32 s19, s21, 21846
    s_lshr_b32 s19, s19, 16
    s_mul_i32 s18, s19, 3
    s_sub_u32 s18, s21, s18
    s_mul_i32 s22, s19, 6144
    s_add_u32 s20, s20, s22
L_p1_dec:
    s_lshl_b32 s22, s18, 11
    s_add_u32 s20, s20, s22
    s_mov_b32 s24, s14
    s_mov_b32 s25, s15
    s_mov_b32 s26, s17
    s_mov_b32 s27, 0x00020000
    s_mov_b32 s28, s12
    s_mov_b32 s29, s13
    s_mov_b32 s30, 4964352
    s_mov_b32 s31, 0x00020000
    v_lshrrev_b32 v31, 6, v0
    s_nop 0
    v_readfirstlane_b32 s32, v31
    s_mul_i32 s33, s19, 80
    s_mul_i32 s34, s32, 20
    s_add_u32 s33, s33, s34
    s_mul_i32 s35, s33, s16
    s_mov_b32 s40, s4
    s_mov_b32 s41, s5
    s_mov_b32 s42, 1280
    s_mov_b32 s43, 0x00020000
    v_and_b32 v1, 63, v0
    v_mul_u32_u24 v2, 20, v1
    buffer_load_dword v3, v2, s[40:43], 0 offen offset:0
    buffer_load_dword v4, v2, s[40:43], 0 offen offset:4
    buffer_load_dword v5, v2, s[40:43], 0 offen offset:8
    buffer_load_dword v6, v2, s[40:43], 0 offen offset:12
    buffer_load_dword v7, v2, s[40:43], 0 offen offset:16
    v_lshlrev_b32 v30, 2, v1
    v_lshlrev_b32 v55, 4, v1
    s_lshl_b32 s34, s18, 10
    v_add_u32 v55, s34, v55
    buffer_load_dwordx4 v[56:59], v55, s[24:27], s35 offen
    s_add_u32 s35, s35, s16
    buffer_load_dwordx4 v[60:63], v55, s[24:27], s35 offen
    s_add_u32 s35, s35, s16
    buffer_load_dwordx4 v[64:67], v55, s[24:27], s35 offen
    s_add_u32 s35, s35, s16
    buffer_load_dwordx4 v[68:71], v55, s[24:27], s35 offen
    s_add_u32 s35, s35, s16
    buffer_load_dwordx4 v[72:75], v55, s[24:27], s35 offen
    s_add_u32 s35, s35, s16
    buffer_load_dwordx4 v[76:79], v55, s[24:27], s35 offen
    s_add_u32 s35, s35, s16
    buffer_load_dwordx4 v[80:83], v55, s[24:27], s35 offen
    s_add_u32 s35, s35, s16
    buffer_load_dwordx4 v[84:87], v55, s[24:27], s35 offen
    s_add_u32 s35, s35, s16
    buffer_load_dwordx4 v[88:91], v55, s[24:27], s35 offen
    s_add_u32 s35, s35, s16
    buffer_load_dwordx4 v[92:95], v55, s[24:27], s35 offen
    s_add_u32 s35, s35, s16
    buffer_load_dwordx4 v[96:99], v55, s[24:27], s35 offen
    s_add_u32 s35, s35, s16
    buffer_load_dwordx4 v[100:103], v55, s[24:27], s35 offen
    s_add_u32 s35, s35, s16
    buffer_load_dwordx4 v[104:107], v55, s[24:27], s35 offen
    s_add_u32 s35, s35, s16
    buffer_load_dwordx4 v[108:111], v55, s[24:27], s35 offen
    s_add_u32 s35, s35, s16
    buffer_load_dwordx4 v[112:115], v55, s[24:27], s35 offen
    s_add_u32 s35, s35, s16
    buffer_load_dwordx4 v[116:119], v55, s[24:27], s35 offen
    s_add_u32 s35, s35, s16
    buffer_load_dwordx4 v[120:123], v55, s[24:27], s35 offen
    s_add_u32 s35, s35, s16
    buffer_load_dwordx4 v[124:127], v55, s[24:27], s35 offen
    s_add_u32 s35, s35, s16
    buffer_load_dwordx4 v[128:131], v55, s[24:27], s35 offen
    s_add_u32 s35, s35, s16
    buffer_load_dwordx4 v[132:135], v55, s[24:27], s35 offen
    s_waitcnt vmcnt(20)
    v_lshlrev_b32 v10, 16, v3
    v_and_b32 v11, 0xffff0000, v3
    v_lshlrev_b32 v12, 16, v4
    v_and_b32 v13, 0xffff0000, v4
    v_lshlrev_b32 v14, 16, v5
    v_and_b32 v15, 0xffff0000, v5
    v_lshlrev_b32 v16, 16, v6
    v_and_b32 v17, 0xffff0000, v6
    v_lshlrev_b32 v18, 16, v7
    v_and_b32 v19, 0xffff0000, v7
    v_add_f32 v20, v10, v11
    v_add_f32 v20, v20, v12
    v_add_f32 v20, v20, v13
    v_add_f32 v20, v20, v14
    v_add_f32 v20, v20, v15
    v_add_f32 v20, v20, v16
    v_add_f32 v20, v20, v17
    v_add_f32 v20, v20, v18
    v_add_f32 v20, v20, v19
    v_xor_b32 v21, 4, v30
    ds_bpermute_b32 v21, v21, v20
    s_waitcnt lgkmcnt(0)
    v_add_f32 v20, v20, v21
    v_xor_b32 v21, 8, v30
    ds_bpermute_b32 v21, v21, v20
    s_waitcnt lgkmcnt(0)
    v_add_f32 v20, v20, v21
    v_xor_b32 v21, 16, v30
    ds_bpermute_b32 v21, v21, v20
    s_waitcnt lgkmcnt(0)
    v_add_f32 v20, v20, v21
    v_xor_b32 v21, 32, v30
    ds_bpermute_b32 v21, v21, v20
    s_waitcnt lgkmcnt(0)
    v_add_f32 v20, v20, v21
    v_xor_b32 v21, 64, v30
    ds_bpermute_b32 v21, v21, v20
    s_waitcnt lgkmcnt(0)
    v_add_f32 v20, v20, v21
    v_xor_b32 v21, 128, v30
    ds_bpermute_b32 v21, v21, v20
    s_waitcnt lgkmcnt(0)
    v_add_f32 v20, v20, v21
    v_mul_f32 v20, 0x3acccccd, v20
    v_sub_f32 v22, v10, v20
    v_mul_f32 v23, v22, v22
    v_sub_f32 v22, v11, v20
    v_fmac_f32 v23, v22, v22
    v_sub_f32 v22, v12, v20
    v_fmac_f32 v23, v22, v22
    v_sub_f32 v22, v13, v20
    v_fmac_f32 v23, v22, v22
    v_sub_f32 v22, v14, v20
    v_fmac_f32 v23, v22, v22
    v_sub_f32 v22, v15, v20
    v_fmac_f32 v23, v22, v22
    v_sub_f32 v22, v16, v20
    v_fmac_f32 v23, v22, v22
    v_sub_f32 v22, v17, v20
    v_fmac_f32 v23, v22, v22
    v_sub_f32 v22, v18, v20
    v_fmac_f32 v23, v22, v22
    v_sub_f32 v22, v19, v20
    v_fmac_f32 v23, v22, v22
    v_xor_b32 v21, 4, v30
    ds_bpermute_b32 v21, v21, v23
    s_waitcnt lgkmcnt(0)
    v_add_f32 v23, v23, v21
    v_xor_b32 v21, 8, v30
    ds_bpermute_b32 v21, v21, v23
    s_waitcnt lgkmcnt(0)
    v_add_f32 v23, v23, v21
    v_xor_b32 v21, 16, v30
    ds_bpermute_b32 v21, v21, v23
    s_waitcnt lgkmcnt(0)
    v_add_f32 v23, v23, v21
    v_xor_b32 v21, 32, v30
    ds_bpermute_b32 v21, v21, v23
    s_waitcnt lgkmcnt(0)
    v_add_f32 v23, v23, v21
    v_xor_b32 v21, 64, v30
    ds_bpermute_b32 v21, v21, v23
    s_waitcnt lgkmcnt(0)
    v_add_f32 v23, v23, v21
    v_xor_b32 v21, 128, v30
    ds_bpermute_b32 v21, v21, v23
    s_waitcnt lgkmcnt(0)
    v_add_f32 v23, v23, v21
    v_mul_f32 v23, 0x3acccccd, v23
    v_cvt_pk_bf16_f32 v21, v20, v20
    v_lshlrev_b32 v20, 16, v21
    v_cvt_pk_bf16_f32 v21, v23, v23
    v_lshlrev_b32 v23, 16, v21
    v_add_f32 v23, 0x3727c5ac, v23
    v_cvt_pk_bf16_f32 v21, v23, v23
    v_lshlrev_b32 v23, 16, v21
    v_sqrt_f32 v23, v23
    s_nop 0
    v_cvt_pk_bf16_f32 v21, v23, v23
    v_lshlrev_b32 v23, 16, v21
    v_rcp_f32 v24, v23
    s_nop 0
    v_sub_f32 v25, v10, v20
    v_cvt_pk_bf16_f32 v21, v25, v25
    v_lshlrev_b32 v25, 16, v21
    v_mul_f32 v26, v25, v24
    v_fma_f32 v27, -v26, v23, v25
    v_fma_f32 v26, v27, v24, v26
    v_cvt_pk_bf16_f32 v21, v26, v26
    v_lshlrev_b32 v26, 16, v21
    v_mov_b32 v10, v26
    v_sub_f32 v25, v11, v20
    v_cvt_pk_bf16_f32 v21, v25, v25
    v_lshlrev_b32 v25, 16, v21
    v_mul_f32 v26, v25, v24
    v_fma_f32 v27, -v26, v23, v25
    v_fma_f32 v26, v27, v24, v26
    v_cvt_pk_bf16_f32 v21, v26, v26
    v_lshlrev_b32 v26, 16, v21
    v_mov_b32 v11, v26
    v_sub_f32 v25, v12, v20
    v_cvt_pk_bf16_f32 v21, v25, v25
    v_lshlrev_b32 v25, 16, v21
    v_mul_f32 v26, v25, v24
    v_fma_f32 v27, -v26, v23, v25
    v_fma_f32 v26, v27, v24, v26
    v_cvt_pk_bf16_f32 v21, v26, v26
    v_lshlrev_b32 v26, 16, v21
    v_mov_b32 v12, v26
    v_sub_f32 v25, v13, v20
    v_cvt_pk_bf16_f32 v21, v25, v25
    v_lshlrev_b32 v25, 16, v21
    v_mul_f32 v26, v25, v24
    v_fma_f32 v27, -v26, v23, v25
    v_fma_f32 v26, v27, v24, v26
    v_cvt_pk_bf16_f32 v21, v26, v26
    v_lshlrev_b32 v26, 16, v21
    v_mov_b32 v13, v26
    v_sub_f32 v25, v14, v20
    v_cvt_pk_bf16_f32 v21, v25, v25
    v_lshlrev_b32 v25, 16, v21
    v_mul_f32 v26, v25, v24
    v_fma_f32 v27, -v26, v23, v25
    v_fma_f32 v26, v27, v24, v26
    v_cvt_pk_bf16_f32 v21, v26, v26
    v_lshlrev_b32 v26, 16, v21
    v_mov_b32 v14, v26
    v_sub_f32 v25, v15, v20
    v_cvt_pk_bf16_f32 v21, v25, v25
    v_lshlrev_b32 v25, 16, v21
    v_mul_f32 v26, v25, v24
    v_fma_f32 v27, -v26, v23, v25
    v_fma_f32 v26, v27, v24, v26
    v_cvt_pk_bf16_f32 v21, v26, v26
    v_lshlrev_b32 v26, 16, v21
    v_mov_b32 v15, v26
    v_sub_f32 v25, v16, v20
    v_cvt_pk_bf16_f32 v21, v25, v25
    v_lshlrev_b32 v25, 16, v21
    v_mul_f32 v26, v25, v24
    v_fma_f32 v27, -v26, v23, v25
    v_fma_f32 v26, v27, v24, v26
    v_cvt_pk_bf16_f32 v21, v26, v26
    v_lshlrev_b32 v26, 16, v21
    v_mov_b32 v16, v26
    v_sub_f32 v25, v17, v20
    v_cvt_pk_bf16_f32 v21, v25, v25
    v_lshlrev_b32 v25, 16, v21
    v_mul_f32 v26, v25, v24
    v_fma_f32 v27, -v26, v23, v25
    v_fma_f32 v26, v27, v24, v26
    v_cvt_pk_bf16_f32 v21, v26, v26
    v_lshlrev_b32 v26, 16, v21
    v_mov_b32 v17, v26
    v_sub_f32 v25, v18, v20
    v_cvt_pk_bf16_f32 v21, v25, v25
    v_lshlrev_b32 v25, 16, v21
    v_mul_f32 v26, v25, v24
    v_fma_f32 v27, -v26, v23, v25
    v_fma_f32 v26, v27, v24, v26
    v_cvt_pk_bf16_f32 v21, v26, v26
    v_lshlrev_b32 v26, 16, v21
    v_mov_b32 v18, v26
    v_sub_f32 v25, v19, v20
    v_cvt_pk_bf16_f32 v21, v25, v25
    v_lshlrev_b32 v25, 16, v21
    v_mul_f32 v26, v25, v24
    v_fma_f32 v27, -v26, v23, v25
    v_fma_f32 v26, v27, v24, v26
    v_cvt_pk_bf16_f32 v21, v26, v26
    v_lshlrev_b32 v26, 16, v21
    v_mov_b32 v19, v26
    v_mul_u32_u24 v28, 40, v1
    ds_write_b32 v28, v10 offset:0
    ds_write_b32 v28, v11 offset:4
    ds_write_b32 v28, v12 offset:8
    ds_write_b32 v28, v13 offset:12
    ds_write_b32 v28, v14 offset:16
    ds_write_b32 v28, v15 offset:20
    ds_write_b32 v28, v16 offset:24
    ds_write_b32 v28, v17 offset:28
    ds_write_b32 v28, v18 offset:32
    ds_write_b32 v28, v19 offset:36
    s_waitcnt lgkmcnt(0)
    s_barrier
    s_lshl_b32 s34, s33, 2
    v_mov_b32 v31, s34
    ds_read_b128 v[32:35], v31 offset:0
    ds_read_b128 v[36:39], v31 offset:16
    ds_read_b128 v[40:43], v31 offset:32
    ds_read_b128 v[44:47], v31 offset:48
    ds_read_b128 v[48:51], v31 offset:64
    v_mov_b32 v140, 0
    v_mov_b32 v141, 0
    v_mov_b32 v142, 0
    v_mov_b32 v143, 0
    v_mov_b32 v144, 0
    v_mov_b32 v145, 0
    v_mov_b32 v146, 0
    v_mov_b32 v147, 0
    s_waitcnt lgkmcnt(0)
    s_waitcnt vmcnt(19)
    v_lshlrev_b32 v3, 16, v56
    v_and_b32 v4, 0xffff0000, v56
    v_fmac_f32 v140, v32, v3
    v_fmac_f32 v141, v32, v4
    v_lshlrev_b32 v3, 16, v57
    v_and_b32 v4, 0xffff0000, v57
    v_fmac_f32 v142, v32, v3
    v_fmac_f32 v143, v32, v4
    v_lshlrev_b32 v3, 16, v58
    v_and_b32 v4, 0xffff0000, v58
    v_fmac_f32 v144, v32, v3
    v_fmac_f32 v145, v32, v4
    v_lshlrev_b32 v3, 16, v59
    v_and_b32 v4, 0xffff0000, v59
    v_fmac_f32 v146, v32, v3
    v_fmac_f32 v147, v32, v4
    s_waitcnt vmcnt(18)
    v_lshlrev_b32 v3, 16, v60
    v_and_b32 v4, 0xffff0000, v60
    v_fmac_f32 v140, v33, v3
    v_fmac_f32 v141, v33, v4
    v_lshlrev_b32 v3, 16, v61
    v_and_b32 v4, 0xffff0000, v61
    v_fmac_f32 v142, v33, v3
    v_fmac_f32 v143, v33, v4
    v_lshlrev_b32 v3, 16, v62
    v_and_b32 v4, 0xffff0000, v62
    v_fmac_f32 v144, v33, v3
    v_fmac_f32 v145, v33, v4
    v_lshlrev_b32 v3, 16, v63
    v_and_b32 v4, 0xffff0000, v63
    v_fmac_f32 v146, v33, v3
    v_fmac_f32 v147, v33, v4
    s_waitcnt vmcnt(17)
    v_lshlrev_b32 v3, 16, v64
    v_and_b32 v4, 0xffff0000, v64
    v_fmac_f32 v140, v34, v3
    v_fmac_f32 v141, v34, v4
    v_lshlrev_b32 v3, 16, v65
    v_and_b32 v4, 0xffff0000, v65
    v_fmac_f32 v142, v34, v3
    v_fmac_f32 v143, v34, v4
    v_lshlrev_b32 v3, 16, v66
    v_and_b32 v4, 0xffff0000, v66
    v_fmac_f32 v144, v34, v3
    v_fmac_f32 v145, v34, v4
    v_lshlrev_b32 v3, 16, v67
    v_and_b32 v4, 0xffff0000, v67
    v_fmac_f32 v146, v34, v3
    v_fmac_f32 v147, v34, v4
    s_waitcnt vmcnt(16)
    v_lshlrev_b32 v3, 16, v68
    v_and_b32 v4, 0xffff0000, v68
    v_fmac_f32 v140, v35, v3
    v_fmac_f32 v141, v35, v4
    v_lshlrev_b32 v3, 16, v69
    v_and_b32 v4, 0xffff0000, v69
    v_fmac_f32 v142, v35, v3
    v_fmac_f32 v143, v35, v4
    v_lshlrev_b32 v3, 16, v70
    v_and_b32 v4, 0xffff0000, v70
    v_fmac_f32 v144, v35, v3
    v_fmac_f32 v145, v35, v4
    v_lshlrev_b32 v3, 16, v71
    v_and_b32 v4, 0xffff0000, v71
    v_fmac_f32 v146, v35, v3
    v_fmac_f32 v147, v35, v4
    s_waitcnt vmcnt(15)
    v_lshlrev_b32 v3, 16, v72
    v_and_b32 v4, 0xffff0000, v72
    v_fmac_f32 v140, v36, v3
    v_fmac_f32 v141, v36, v4
    v_lshlrev_b32 v3, 16, v73
    v_and_b32 v4, 0xffff0000, v73
    v_fmac_f32 v142, v36, v3
    v_fmac_f32 v143, v36, v4
    v_lshlrev_b32 v3, 16, v74
    v_and_b32 v4, 0xffff0000, v74
    v_fmac_f32 v144, v36, v3
    v_fmac_f32 v145, v36, v4
    v_lshlrev_b32 v3, 16, v75
    v_and_b32 v4, 0xffff0000, v75
    v_fmac_f32 v146, v36, v3
    v_fmac_f32 v147, v36, v4
    s_waitcnt vmcnt(14)
    v_lshlrev_b32 v3, 16, v76
    v_and_b32 v4, 0xffff0000, v76
    v_fmac_f32 v140, v37, v3
    v_fmac_f32 v141, v37, v4
    v_lshlrev_b32 v3, 16, v77
    v_and_b32 v4, 0xffff0000, v77
    v_fmac_f32 v142, v37, v3
    v_fmac_f32 v143, v37, v4
    v_lshlrev_b32 v3, 16, v78
    v_and_b32 v4, 0xffff0000, v78
    v_fmac_f32 v144, v37, v3
    v_fmac_f32 v145, v37, v4
    v_lshlrev_b32 v3, 16, v79
    v_and_b32 v4, 0xffff0000, v79
    v_fmac_f32 v146, v37, v3
    v_fmac_f32 v147, v37, v4
    s_waitcnt vmcnt(13)
    v_lshlrev_b32 v3, 16, v80
    v_and_b32 v4, 0xffff0000, v80
    v_fmac_f32 v140, v38, v3
    v_fmac_f32 v141, v38, v4
    v_lshlrev_b32 v3, 16, v81
    v_and_b32 v4, 0xffff0000, v81
    v_fmac_f32 v142, v38, v3
    v_fmac_f32 v143, v38, v4
    v_lshlrev_b32 v3, 16, v82
    v_and_b32 v4, 0xffff0000, v82
    v_fmac_f32 v144, v38, v3
    v_fmac_f32 v145, v38, v4
    v_lshlrev_b32 v3, 16, v83
    v_and_b32 v4, 0xffff0000, v83
    v_fmac_f32 v146, v38, v3
    v_fmac_f32 v147, v38, v4
    s_waitcnt vmcnt(12)
    v_lshlrev_b32 v3, 16, v84
    v_and_b32 v4, 0xffff0000, v84
    v_fmac_f32 v140, v39, v3
    v_fmac_f32 v141, v39, v4
    v_lshlrev_b32 v3, 16, v85
    v_and_b32 v4, 0xffff0000, v85
    v_fmac_f32 v142, v39, v3
    v_fmac_f32 v143, v39, v4
    v_lshlrev_b32 v3, 16, v86
    v_and_b32 v4, 0xffff0000, v86
    v_fmac_f32 v144, v39, v3
    v_fmac_f32 v145, v39, v4
    v_lshlrev_b32 v3, 16, v87
    v_and_b32 v4, 0xffff0000, v87
    v_fmac_f32 v146, v39, v3
    v_fmac_f32 v147, v39, v4
    s_waitcnt vmcnt(11)
    v_lshlrev_b32 v3, 16, v88
    v_and_b32 v4, 0xffff0000, v88
    v_fmac_f32 v140, v40, v3
    v_fmac_f32 v141, v40, v4
    v_lshlrev_b32 v3, 16, v89
    v_and_b32 v4, 0xffff0000, v89
    v_fmac_f32 v142, v40, v3
    v_fmac_f32 v143, v40, v4
    v_lshlrev_b32 v3, 16, v90
    v_and_b32 v4, 0xffff0000, v90
    v_fmac_f32 v144, v40, v3
    v_fmac_f32 v145, v40, v4
    v_lshlrev_b32 v3, 16, v91
    v_and_b32 v4, 0xffff0000, v91
    v_fmac_f32 v146, v40, v3
    v_fmac_f32 v147, v40, v4
    s_waitcnt vmcnt(10)
    v_lshlrev_b32 v3, 16, v92
    v_and_b32 v4, 0xffff0000, v92
    v_fmac_f32 v140, v41, v3
    v_fmac_f32 v141, v41, v4
    v_lshlrev_b32 v3, 16, v93
    v_and_b32 v4, 0xffff0000, v93
    v_fmac_f32 v142, v41, v3
    v_fmac_f32 v143, v41, v4
    v_lshlrev_b32 v3, 16, v94
    v_and_b32 v4, 0xffff0000, v94
    v_fmac_f32 v144, v41, v3
    v_fmac_f32 v145, v41, v4
    v_lshlrev_b32 v3, 16, v95
    v_and_b32 v4, 0xffff0000, v95
    v_fmac_f32 v146, v41, v3
    v_fmac_f32 v147, v41, v4
    s_waitcnt vmcnt(9)
    v_lshlrev_b32 v3, 16, v96
    v_and_b32 v4, 0xffff0000, v96
    v_fmac_f32 v140, v42, v3
    v_fmac_f32 v141, v42, v4
    v_lshlrev_b32 v3, 16, v97
    v_and_b32 v4, 0xffff0000, v97
    v_fmac_f32 v142, v42, v3
    v_fmac_f32 v143, v42, v4
    v_lshlrev_b32 v3, 16, v98
    v_and_b32 v4, 0xffff0000, v98
    v_fmac_f32 v144, v42, v3
    v_fmac_f32 v145, v42, v4
    v_lshlrev_b32 v3, 16, v99
    v_and_b32 v4, 0xffff0000, v99
    v_fmac_f32 v146, v42, v3
    v_fmac_f32 v147, v42, v4
    s_waitcnt vmcnt(8)
    v_lshlrev_b32 v3, 16, v100
    v_and_b32 v4, 0xffff0000, v100
    v_fmac_f32 v140, v43, v3
    v_fmac_f32 v141, v43, v4
    v_lshlrev_b32 v3, 16, v101
    v_and_b32 v4, 0xffff0000, v101
    v_fmac_f32 v142, v43, v3
    v_fmac_f32 v143, v43, v4
    v_lshlrev_b32 v3, 16, v102
    v_and_b32 v4, 0xffff0000, v102
    v_fmac_f32 v144, v43, v3
    v_fmac_f32 v145, v43, v4
    v_lshlrev_b32 v3, 16, v103
    v_and_b32 v4, 0xffff0000, v103
    v_fmac_f32 v146, v43, v3
    v_fmac_f32 v147, v43, v4
    s_waitcnt vmcnt(7)
    v_lshlrev_b32 v3, 16, v104
    v_and_b32 v4, 0xffff0000, v104
    v_fmac_f32 v140, v44, v3
    v_fmac_f32 v141, v44, v4
    v_lshlrev_b32 v3, 16, v105
    v_and_b32 v4, 0xffff0000, v105
    v_fmac_f32 v142, v44, v3
    v_fmac_f32 v143, v44, v4
    v_lshlrev_b32 v3, 16, v106
    v_and_b32 v4, 0xffff0000, v106
    v_fmac_f32 v144, v44, v3
    v_fmac_f32 v145, v44, v4
    v_lshlrev_b32 v3, 16, v107
    v_and_b32 v4, 0xffff0000, v107
    v_fmac_f32 v146, v44, v3
    v_fmac_f32 v147, v44, v4
    s_waitcnt vmcnt(6)
    v_lshlrev_b32 v3, 16, v108
    v_and_b32 v4, 0xffff0000, v108
    v_fmac_f32 v140, v45, v3
    v_fmac_f32 v141, v45, v4
    v_lshlrev_b32 v3, 16, v109
    v_and_b32 v4, 0xffff0000, v109
    v_fmac_f32 v142, v45, v3
    v_fmac_f32 v143, v45, v4
    v_lshlrev_b32 v3, 16, v110
    v_and_b32 v4, 0xffff0000, v110
    v_fmac_f32 v144, v45, v3
    v_fmac_f32 v145, v45, v4
    v_lshlrev_b32 v3, 16, v111
    v_and_b32 v4, 0xffff0000, v111
    v_fmac_f32 v146, v45, v3
    v_fmac_f32 v147, v45, v4
    s_waitcnt vmcnt(5)
    v_lshlrev_b32 v3, 16, v112
    v_and_b32 v4, 0xffff0000, v112
    v_fmac_f32 v140, v46, v3
    v_fmac_f32 v141, v46, v4
    v_lshlrev_b32 v3, 16, v113
    v_and_b32 v4, 0xffff0000, v113
    v_fmac_f32 v142, v46, v3
    v_fmac_f32 v143, v46, v4
    v_lshlrev_b32 v3, 16, v114
    v_and_b32 v4, 0xffff0000, v114
    v_fmac_f32 v144, v46, v3
    v_fmac_f32 v145, v46, v4
    v_lshlrev_b32 v3, 16, v115
    v_and_b32 v4, 0xffff0000, v115
    v_fmac_f32 v146, v46, v3
    v_fmac_f32 v147, v46, v4
    s_waitcnt vmcnt(4)
    v_lshlrev_b32 v3, 16, v116
    v_and_b32 v4, 0xffff0000, v116
    v_fmac_f32 v140, v47, v3
    v_fmac_f32 v141, v47, v4
    v_lshlrev_b32 v3, 16, v117
    v_and_b32 v4, 0xffff0000, v117
    v_fmac_f32 v142, v47, v3
    v_fmac_f32 v143, v47, v4
    v_lshlrev_b32 v3, 16, v118
    v_and_b32 v4, 0xffff0000, v118
    v_fmac_f32 v144, v47, v3
    v_fmac_f32 v145, v47, v4
    v_lshlrev_b32 v3, 16, v119
    v_and_b32 v4, 0xffff0000, v119
    v_fmac_f32 v146, v47, v3
    v_fmac_f32 v147, v47, v4
    s_waitcnt vmcnt(3)
    v_lshlrev_b32 v3, 16, v120
    v_and_b32 v4, 0xffff0000, v120
    v_fmac_f32 v140, v48, v3
    v_fmac_f32 v141, v48, v4
    v_lshlrev_b32 v3, 16, v121
    v_and_b32 v4, 0xffff0000, v121
    v_fmac_f32 v142, v48, v3
    v_fmac_f32 v143, v48, v4
    v_lshlrev_b32 v3, 16, v122
    v_and_b32 v4, 0xffff0000, v122
    v_fmac_f32 v144, v48, v3
    v_fmac_f32 v145, v48, v4
    v_lshlrev_b32 v3, 16, v123
    v_and_b32 v4, 0xffff0000, v123
    v_fmac_f32 v146, v48, v3
    v_fmac_f32 v147, v48, v4
    s_waitcnt vmcnt(2)
    v_lshlrev_b32 v3, 16, v124
    v_and_b32 v4, 0xffff0000, v124
    v_fmac_f32 v140, v49, v3
    v_fmac_f32 v141, v49, v4
    v_lshlrev_b32 v3, 16, v125
    v_and_b32 v4, 0xffff0000, v125
    v_fmac_f32 v142, v49, v3
    v_fmac_f32 v143, v49, v4
    v_lshlrev_b32 v3, 16, v126
    v_and_b32 v4, 0xffff0000, v126
    v_fmac_f32 v144, v49, v3
    v_fmac_f32 v145, v49, v4
    v_lshlrev_b32 v3, 16, v127
    v_and_b32 v4, 0xffff0000, v127
    v_fmac_f32 v146, v49, v3
    v_fmac_f32 v147, v49, v4
    s_waitcnt vmcnt(1)
    v_lshlrev_b32 v3, 16, v128
    v_and_b32 v4, 0xffff0000, v128
    v_fmac_f32 v140, v50, v3
    v_fmac_f32 v141, v50, v4
    v_lshlrev_b32 v3, 16, v129
    v_and_b32 v4, 0xffff0000, v129
    v_fmac_f32 v142, v50, v3
    v_fmac_f32 v143, v50, v4
    v_lshlrev_b32 v3, 16, v130
    v_and_b32 v4, 0xffff0000, v130
    v_fmac_f32 v144, v50, v3
    v_fmac_f32 v145, v50, v4
    v_lshlrev_b32 v3, 16, v131
    v_and_b32 v4, 0xffff0000, v131
    v_fmac_f32 v146, v50, v3
    v_fmac_f32 v147, v50, v4
    s_waitcnt vmcnt(0)
    v_lshlrev_b32 v3, 16, v132
    v_and_b32 v4, 0xffff0000, v132
    v_fmac_f32 v140, v51, v3
    v_fmac_f32 v141, v51, v4
    v_lshlrev_b32 v3, 16, v133
    v_and_b32 v4, 0xffff0000, v133
    v_fmac_f32 v142, v51, v3
    v_fmac_f32 v143, v51, v4
    v_lshlrev_b32 v3, 16, v134
    v_and_b32 v4, 0xffff0000, v134
    v_fmac_f32 v144, v51, v3
    v_fmac_f32 v145, v51, v4
    v_lshlrev_b32 v3, 16, v135
    v_and_b32 v4, 0xffff0000, v135
    v_fmac_f32 v146, v51, v3
    v_fmac_f32 v147, v51, v4
    v_lshlrev_b32 v3, 5, v0
    ds_write_b128 v3, v[140:143] offset:2560
    ds_write_b128 v3, v[144:147] offset:2576
    s_waitcnt lgkmcnt(0)
    s_barrier
    v_lshlrev_b32 v3, 3, v0
    ds_read_b64 v[4:5], v3 offset:2560
    ds_read_b64 v[6:7], v3 offset:4608
    ds_read_b64 v[8:9], v3 offset:6656
    ds_read_b64 v[10:11], v3 offset:8704
    s_waitcnt lgkmcnt(0)
    v_add_f32 v4, v4, v6
    v_add_f32 v5, v5, v7
    v_add_f32 v8, v8, v10
    v_add_f32 v9, v9, v11
    v_add_f32 v4, v4, v8
    v_add_f32 v5, v5, v9
    buffer_store_dwordx2 v[4:5], v3, s[28:31], s20 offen
L_p1_end:
    s_endpgm
.globl attn_kernel
.p2align 8
.type attn_kernel,@function
attn_kernel:
    s_cmp_ge_u32 s2, 512
    s_cbranch_scc1 L_at_end
    s_load_dwordx2 s[4:5], s[0:1], 8
    s_load_dwordx2 s[6:7], s[0:1], 16
    s_load_dwordx2 s[8:9], s[0:1], 88
    s_waitcnt lgkmcnt(0)
    s_mov_b32 s12, s4
    s_mov_b32 s13, s5
    s_mov_b32 s14, 402653184
    s_mov_b32 s15, 0x00020000
    s_mov_b32 s16, s6
    s_mov_b32 s17, s7
    s_mov_b32 s18, 402653184
    s_mov_b32 s19, 0x00020000
    s_mov_b32 s20, s8
    s_mov_b32 s21, s9
    s_mov_b32 s22, 4964352
    s_mov_b32 s23, 0x00020000
    s_lshr_b32 s24, s2, 4
    s_and_b32 s25, s2, 15
    v_cmp_gt_u32 vcc, 96, v0
    s_and_saveexec_b64 s[26:27], vcc
    s_cbranch_execz L_at_q_done
    s_mul_i32 s28, s24, 768
    v_lshlrev_b32 v1, 3, v0
    v_add_u32 v1, s28, v1
    buffer_load_dwordx2 v[2:3], v1, s[20:23], 0 offen offset:0
    s_mov_b32 s29, 24576
    buffer_load_dwordx2 v[4:5], v1, s[20:23], s29 offen
    s_add_u32 s29, s29, 24576
    buffer_load_dwordx2 v[6:7], v1, s[20:23], s29 offen
    s_add_u32 s29, s29, 24576
    buffer_load_dwordx2 v[8:9], v1, s[20:23], s29 offen
    s_add_u32 s29, s29, 24576
    buffer_load_dwordx2 v[10:11], v1, s[20:23], s29 offen
    s_add_u32 s29, s29, 24576
    buffer_load_dwordx2 v[12:13], v1, s[20:23], s29 offen
    s_add_u32 s29, s29, 24576
    buffer_load_dwordx2 v[14:15], v1, s[20:23], s29 offen
    s_add_u32 s29, s29, 24576
    buffer_load_dwordx2 v[16:17], v1, s[20:23], s29 offen
    s_waitcnt vmcnt(0)
    v_add_f32 v2, v2, v4
    v_add_f32 v3, v3, v5
    v_add_f32 v2, v2, v6
    v_add_f32 v3, v3, v7
    v_add_f32 v2, v2, v8
    v_add_f32 v3, v3, v9
    v_add_f32 v2, v2, v10
    v_add_f32 v3, v3, v11
    v_add_f32 v2, v2, v12
    v_add_f32 v3, v3, v13
    v_add_f32 v2, v2, v14
    v_add_f32 v3, v3, v15
    v_add_f32 v2, v2, v16
    v_add_f32 v3, v3, v17
    v_cvt_pk_bf16_f32 v4, v2, v3
    v_lshlrev_b32 v5, 2, v0
    ds_write_b32 v5, v4
L_at_q_done:
    s_mov_b64 exec, s[26:27]
    s_waitcnt vmcnt(0) lgkmcnt(0)
    s_barrier
    v_and_b32 v1, 63, v0
    v_and_b32 v2, 7, v1
    v_lshrrev_b32 v3, 3, v1
    v_lshlrev_b32 v4, 4, v2
    ds_read_b128 v[8:11], v4 offset:0
    ds_read_b128 v[12:15], v4 offset:128
    ds_read_b128 v[16:19], v4 offset:256
    v_mul_u32_u24 v5, 384, v3
    v_add_u32 v5, v5, v4
    v_lshrrev_b32 v6, 6, v0
    s_nop 0
    v_readfirstlane_b32 s30, v6
    s_mul_i32 s31, s24, 32768
    s_mul_i32 s32, s25, 2048
    s_add_u32 s31, s31, s32
    s_mul_i32 s32, s30, 512
    s_add_u32 s31, s31, s32
    s_mul_i32 s31, s31, 384
    s_add_u32 s36, s31, 0
    s_add_u32 s37, s31, 3072
    s_add_u32 s38, s31, 6144
    s_add_u32 s39, s31, 9216
    s_add_u32 s40, s31, 12288
    s_add_u32 s41, s31, 15360
    s_add_u32 s42, s31, 18432
    s_add_u32 s43, s31, 21504
    v_mov_b32 v216, 0
    v_mov_b32 v217, 0
    v_mov_b32 v218, 0
    v_mov_b32 v219, 0
    v_mov_b32 v220, 0
    v_mov_b32 v221, 0
    v_mov_b32 v222, 0
    v_mov_b32 v223, 0
    v_mov_b32 v224, 0
    v_mov_b32 v225, 0
    v_mov_b32 v226, 0
    v_mov_b32 v227, 0
    v_mov_b32 v228, 0
    v_mov_b32 v229, 0
    v_mov_b32 v230, 0
    v_mov_b32 v231, 0
    v_mov_b32 v232, 0
    v_mov_b32 v233, 0
    v_mov_b32 v234, 0
    v_mov_b32 v235, 0
    v_mov_b32 v236, 0
    v_mov_b32 v237, 0
    v_mov_b32 v238, 0
    v_mov_b32 v239, 0
    v_mov_b32 v248, 0xff800000
    v_mov_b32 v249, 0
    s_waitcnt lgkmcnt(0)
    buffer_load_dwordx4 v[24:27], v5, s[12:15], s36 offen offset:0 nt
    buffer_load_dwordx4 v[28:31], v5, s[12:15], s36 offen offset:128 nt
    buffer_load_dwordx4 v[32:35], v5, s[12:15], s36 offen offset:256 nt
    buffer_load_dwordx4 v[36:39], v5, s[12:15], s37 offen offset:0 nt
    buffer_load_dwordx4 v[40:43], v5, s[12:15], s37 offen offset:128 nt
    buffer_load_dwordx4 v[44:47], v5, s[12:15], s37 offen offset:256 nt
    buffer_load_dwordx4 v[48:51], v5, s[12:15], s38 offen offset:0 nt
    buffer_load_dwordx4 v[52:55], v5, s[12:15], s38 offen offset:128 nt
    buffer_load_dwordx4 v[56:59], v5, s[12:15], s38 offen offset:256 nt
    buffer_load_dwordx4 v[60:63], v5, s[12:15], s39 offen offset:0 nt
    buffer_load_dwordx4 v[64:67], v5, s[12:15], s39 offen offset:128 nt
    buffer_load_dwordx4 v[68:71], v5, s[12:15], s39 offen offset:256 nt
    buffer_load_dwordx4 v[72:75], v5, s[12:15], s40 offen offset:0 nt
    buffer_load_dwordx4 v[76:79], v5, s[12:15], s40 offen offset:128 nt
    buffer_load_dwordx4 v[80:83], v5, s[12:15], s40 offen offset:256 nt
    buffer_load_dwordx4 v[84:87], v5, s[12:15], s41 offen offset:0 nt
    buffer_load_dwordx4 v[88:91], v5, s[12:15], s41 offen offset:128 nt
    buffer_load_dwordx4 v[92:95], v5, s[12:15], s41 offen offset:256 nt
    buffer_load_dwordx4 v[96:99], v5, s[12:15], s42 offen offset:0 nt
    buffer_load_dwordx4 v[100:103], v5, s[12:15], s42 offen offset:128 nt
    buffer_load_dwordx4 v[104:107], v5, s[12:15], s42 offen offset:256 nt
    buffer_load_dwordx4 v[108:111], v5, s[12:15], s43 offen offset:0 nt
    buffer_load_dwordx4 v[112:115], v5, s[12:15], s43 offen offset:128 nt
    buffer_load_dwordx4 v[116:119], v5, s[12:15], s43 offen offset:256 nt
    buffer_load_dwordx4 v[120:123], v5, s[16:19], s36 offen offset:0 nt
    buffer_load_dwordx4 v[124:127], v5, s[16:19], s36 offen offset:128 nt
    buffer_load_dwordx4 v[128:131], v5, s[16:19], s36 offen offset:256 nt
    buffer_load_dwordx4 v[132:135], v5, s[16:19], s37 offen offset:0 nt
    buffer_load_dwordx4 v[136:139], v5, s[16:19], s37 offen offset:128 nt
    buffer_load_dwordx4 v[140:143], v5, s[16:19], s37 offen offset:256 nt
    buffer_load_dwordx4 v[144:147], v5, s[16:19], s38 offen offset:0 nt
    buffer_load_dwordx4 v[148:151], v5, s[16:19], s38 offen offset:128 nt
    buffer_load_dwordx4 v[152:155], v5, s[16:19], s38 offen offset:256 nt
    buffer_load_dwordx4 v[156:159], v5, s[16:19], s39 offen offset:0 nt
    buffer_load_dwordx4 v[160:163], v5, s[16:19], s39 offen offset:128 nt
    buffer_load_dwordx4 v[164:167], v5, s[16:19], s39 offen offset:256 nt
    buffer_load_dwordx4 v[168:171], v5, s[16:19], s40 offen offset:0 nt
    buffer_load_dwordx4 v[172:175], v5, s[16:19], s40 offen offset:128 nt
    buffer_load_dwordx4 v[176:179], v5, s[16:19], s40 offen offset:256 nt
    buffer_load_dwordx4 v[180:183], v5, s[16:19], s41 offen offset:0 nt
    buffer_load_dwordx4 v[184:187], v5, s[16:19], s41 offen offset:128 nt
    buffer_load_dwordx4 v[188:191], v5, s[16:19], s41 offen offset:256 nt
    buffer_load_dwordx4 v[192:195], v5, s[16:19], s42 offen offset:0 nt
    buffer_load_dwordx4 v[196:199], v5, s[16:19], s42 offen offset:128 nt
    buffer_load_dwordx4 v[200:203], v5, s[16:19], s42 offen offset:256 nt
    buffer_load_dwordx4 v[204:207], v5, s[16:19], s43 offen offset:0 nt
    buffer_load_dwordx4 v[208:211], v5, s[16:19], s43 offen offset:128 nt
    buffer_load_dwordx4 v[212:215], v5, s[16:19], s43 offen offset:256 nt
    s_mov_b32 s33, 8
L_at_loop:
    s_waitcnt vmcnt(24)
    v_dot2_f32_bf16 v240, v24, v8, 0
    v_dot2_f32_bf16 v241, v36, v8, 0
    v_dot2_f32_bf16 v242, v48, v8, 0
    v_dot2_f32_bf16 v243, v60, v8, 0
    v_dot2_f32_bf16 v244, v72, v8, 0
    v_dot2_f32_bf16 v245, v84, v8, 0
    v_dot2_f32_bf16 v246, v96, v8, 0
    v_dot2_f32_bf16 v247, v108, v8, 0
    v_dot2c_f32_bf16 v240, v25, v9
    v_dot2c_f32_bf16 v241, v37, v9
    v_dot2c_f32_bf16 v242, v49, v9
    v_dot2c_f32_bf16 v243, v61, v9
    v_dot2c_f32_bf16 v244, v73, v9
    v_dot2c_f32_bf16 v245, v85, v9
    v_dot2c_f32_bf16 v246, v97, v9
    v_dot2c_f32_bf16 v247, v109, v9
    v_dot2c_f32_bf16 v240, v26, v10
    v_dot2c_f32_bf16 v241, v38, v10
    v_dot2c_f32_bf16 v242, v50, v10
    v_dot2c_f32_bf16 v243, v62, v10
    v_dot2c_f32_bf16 v244, v74, v10
    v_dot2c_f32_bf16 v245, v86, v10
    v_dot2c_f32_bf16 v246, v98, v10
    v_dot2c_f32_bf16 v247, v110, v10
    v_dot2c_f32_bf16 v240, v27, v11
    v_dot2c_f32_bf16 v241, v39, v11
    v_dot2c_f32_bf16 v242, v51, v11
    v_dot2c_f32_bf16 v243, v63, v11
    v_dot2c_f32_bf16 v244, v75, v11
    v_dot2c_f32_bf16 v245, v87, v11
    v_dot2c_f32_bf16 v246, v99, v11
    v_dot2c_f32_bf16 v247, v111, v11
    v_dot2c_f32_bf16 v240, v28, v12
    v_dot2c_f32_bf16 v241, v40, v12
    v_dot2c_f32_bf16 v242, v52, v12
    v_dot2c_f32_bf16 v243, v64, v12
    v_dot2c_f32_bf16 v244, v76, v12
    v_dot2c_f32_bf16 v245, v88, v12
    v_dot2c_f32_bf16 v246, v100, v12
    v_dot2c_f32_bf16 v247, v112, v12
    v_dot2c_f32_bf16 v240, v29, v13
    v_dot2c_f32_bf16 v241, v41, v13
    v_dot2c_f32_bf16 v242, v53, v13
    v_dot2c_f32_bf16 v243, v65, v13
    v_dot2c_f32_bf16 v244, v77, v13
    v_dot2c_f32_bf16 v245, v89, v13
    v_dot2c_f32_bf16 v246, v101, v13
    v_dot2c_f32_bf16 v247, v113, v13
    v_dot2c_f32_bf16 v240, v30, v14
    v_dot2c_f32_bf16 v241, v42, v14
    v_dot2c_f32_bf16 v242, v54, v14
    v_dot2c_f32_bf16 v243, v66, v14
    v_dot2c_f32_bf16 v244, v78, v14
    v_dot2c_f32_bf16 v245, v90, v14
    v_dot2c_f32_bf16 v246, v102, v14
    v_dot2c_f32_bf16 v247, v114, v14
    v_dot2c_f32_bf16 v240, v31, v15
    v_dot2c_f32_bf16 v241, v43, v15
    v_dot2c_f32_bf16 v242, v55, v15
    v_dot2c_f32_bf16 v243, v67, v15
    v_dot2c_f32_bf16 v244, v79, v15
    v_dot2c_f32_bf16 v245, v91, v15
    v_dot2c_f32_bf16 v246, v103, v15
    v_dot2c_f32_bf16 v247, v115, v15
    v_dot2c_f32_bf16 v240, v32, v16
    v_dot2c_f32_bf16 v241, v44, v16
    v_dot2c_f32_bf16 v242, v56, v16
    v_dot2c_f32_bf16 v243, v68, v16
    v_dot2c_f32_bf16 v244, v80, v16
    v_dot2c_f32_bf16 v245, v92, v16
    v_dot2c_f32_bf16 v246, v104, v16
    v_dot2c_f32_bf16 v247, v116, v16
    v_dot2c_f32_bf16 v240, v33, v17
    v_dot2c_f32_bf16 v241, v45, v17
    v_dot2c_f32_bf16 v242, v57, v17
    v_dot2c_f32_bf16 v243, v69, v17
    v_dot2c_f32_bf16 v244, v81, v17
    v_dot2c_f32_bf16 v245, v93, v17
    v_dot2c_f32_bf16 v246, v105, v17
    v_dot2c_f32_bf16 v247, v117, v17
    v_dot2c_f32_bf16 v240, v34, v18
    v_dot2c_f32_bf16 v241, v46, v18
    v_dot2c_f32_bf16 v242, v58, v18
    v_dot2c_f32_bf16 v243, v70, v18
    v_dot2c_f32_bf16 v244, v82, v18
    v_dot2c_f32_bf16 v245, v94, v18
    v_dot2c_f32_bf16 v246, v106, v18
    v_dot2c_f32_bf16 v247, v118, v18
    v_dot2c_f32_bf16 v240, v35, v19
    v_dot2c_f32_bf16 v241, v47, v19
    v_dot2c_f32_bf16 v242, v59, v19
    v_dot2c_f32_bf16 v243, v71, v19
    v_dot2c_f32_bf16 v244, v83, v19
    v_dot2c_f32_bf16 v245, v95, v19
    v_dot2c_f32_bf16 v246, v107, v19
    v_dot2c_f32_bf16 v247, v119, v19
    s_sub_u32 s33, s33, 1
    s_cmp_eq_u32 s33, 0
    s_cbranch_scc1 L_at_skipK
    s_add_u32 s44, s36, 24576
    s_add_u32 s45, s37, 24576
    s_add_u32 s46, s38, 24576
    s_add_u32 s47, s39, 24576
    s_add_u32 s48, s40, 24576
    s_add_u32 s49, s41, 24576
    s_add_u32 s50, s42, 24576
    s_add_u32 s51, s43, 24576
    buffer_load_dwordx4 v[24:27], v5, s[12:15], s44 offen offset:0 nt
    buffer_load_dwordx4 v[28:31], v5, s[12:15], s44 offen offset:128 nt
    buffer_load_dwordx4 v[32:35], v5, s[12:15], s44 offen offset:256 nt
    buffer_load_dwordx4 v[36:39], v5, s[12:15], s45 offen offset:0 nt
    buffer_load_dwordx4 v[40:43], v5, s[12:15], s45 offen offset:128 nt
    buffer_load_dwordx4 v[44:47], v5, s[12:15], s45 offen offset:256 nt
    buffer_load_dwordx4 v[48:51], v5, s[12:15], s46 offen offset:0 nt
    buffer_load_dwordx4 v[52:55], v5, s[12:15], s46 offen offset:128 nt
    buffer_load_dwordx4 v[56:59], v5, s[12:15], s46 offen offset:256 nt
    buffer_load_dwordx4 v[60:63], v5, s[12:15], s47 offen offset:0 nt
    buffer_load_dwordx4 v[64:67], v5, s[12:15], s47 offen offset:128 nt
    buffer_load_dwordx4 v[68:71], v5, s[12:15], s47 offen offset:256 nt
    buffer_load_dwordx4 v[72:75], v5, s[12:15], s48 offen offset:0 nt
    buffer_load_dwordx4 v[76:79], v5, s[12:15], s48 offen offset:128 nt
    buffer_load_dwordx4 v[80:83], v5, s[12:15], s48 offen offset:256 nt
    buffer_load_dwordx4 v[84:87], v5, s[12:15], s49 offen offset:0 nt
    buffer_load_dwordx4 v[88:91], v5, s[12:15], s49 offen offset:128 nt
    buffer_load_dwordx4 v[92:95], v5, s[12:15], s49 offen offset:256 nt
    buffer_load_dwordx4 v[96:99], v5, s[12:15], s50 offen offset:0 nt
    buffer_load_dwordx4 v[100:103], v5, s[12:15], s50 offen offset:128 nt
    buffer_load_dwordx4 v[104:107], v5, s[12:15], s50 offen offset:256 nt
    buffer_load_dwordx4 v[108:111], v5, s[12:15], s51 offen offset:0 nt
    buffer_load_dwordx4 v[112:115], v5, s[12:15], s51 offen offset:128 nt
    buffer_load_dwordx4 v[116:119], v5, s[12:15], s51 offen offset:256 nt
L_at_skipK:
    s_nop 1
    v_add_f32_dpp v240, v240, v240 quad_perm:[1,0,3,2] row_mask:0xf bank_mask:0xf
    v_add_f32_dpp v241, v241, v241 quad_perm:[1,0,3,2] row_mask:0xf bank_mask:0xf
    v_add_f32_dpp v242, v242, v242 quad_perm:[1,0,3,2] row_mask:0xf bank_mask:0xf
    v_add_f32_dpp v243, v243, v243 quad_perm:[1,0,3,2] row_mask:0xf bank_mask:0xf
    v_add_f32_dpp v244, v244, v244 quad_perm:[1,0,3,2] row_mask:0xf bank_mask:0xf
    v_add_f32_dpp v245, v245, v245 quad_perm:[1,0,3,2] row_mask:0xf bank_mask:0xf
    v_add_f32_dpp v246, v246, v246 quad_perm:[1,0,3,2] row_mask:0xf bank_mask:0xf
    v_add_f32_dpp v247, v247, v247 quad_perm:[1,0,3,2] row_mask:0xf bank_mask:0xf
    s_nop 1
    v_add_f32_dpp v240, v240, v240 quad_perm:[2,3,0,1] row_mask:0xf bank_mask:0xf
    v_add_f32_dpp v241, v241, v241 quad_perm:[2,3,0,1] row_mask:0xf bank_mask:0xf
    v_add_f32_dpp v242, v242, v242 quad_perm:[2,3,0,1] row_mask:0xf bank_mask:0xf
    v_add_f32_dpp v243, v243, v243 quad_perm:[2,3,0,1] row_mask:0xf bank_mask:0xf
    v_add_f32_dpp v244, v244, v244 quad_perm:[2,3,0,1] row_mask:0xf bank_mask:0xf
    v_add_f32_dpp v245, v245, v245 quad_perm:[2,3,0,1] row_mask:0xf bank_mask:0xf
    v_add_f32_dpp v246, v246, v246 quad_perm:[2,3,0,1] row_mask:0xf bank_mask:0xf
    v_add_f32_dpp v247, v247, v247 quad_perm:[2,3,0,1] row_mask:0xf bank_mask:0xf
    s_nop 1
    v_add_f32_dpp v240, v240, v240 row_half_mirror row_mask:0xf bank_mask:0xf
    v_add_f32_dpp v241, v241, v241 row_half_mirror row_mask:0xf bank_mask:0xf
    v_add_f32_dpp v242, v242, v242 row_half_mirror row_mask:0xf bank_mask:0xf
    v_add_f32_dpp v243, v243, v243 row_half_mirror row_mask:0xf bank_mask:0xf
    v_add_f32_dpp v244, v244, v244 row_half_mirror row_mask:0xf bank_mask:0xf
    v_add_f32_dpp v245, v245, v245 row_half_mirror row_mask:0xf bank_mask:0xf
    v_add_f32_dpp v246, v246, v246 row_half_mirror row_mask:0xf bank_mask:0xf
    v_add_f32_dpp v247, v247, v247 row_half_mirror row_mask:0xf bank_mask:0xf
    v_cvt_pk_bf16_f32 v250, v240, v241
    v_lshlrev_b32 v240, 16, v250
    v_and_b32 v241, 0xffff0000, v250
    v_mul_f32 v240, 0x3d93cd3a, v240
    v_mul_f32 v241, 0x3d93cd3a, v241
    v_cvt_pk_bf16_f32 v250, v240, v241
    v_lshlrev_b32 v240, 16, v250
    v_and_b32 v241, 0xffff0000, v250
    v_mul_f32 v240, 0x3fb8aa3b, v240
    v_mul_f32 v241, 0x3fb8aa3b, v241
    v_cvt_pk_bf16_f32 v250, v242, v243
    v_lshlrev_b32 v242, 16, v250
    v_and_b32 v243, 0xffff0000, v250
    v_mul_f32 v242, 0x3d93cd3a, v242
    v_mul_f32 v243, 0x3d93cd3a, v243
    v_cvt_pk_bf16_f32 v250, v242, v243
    v_lshlrev_b32 v242, 16, v250
    v_and_b32 v243, 0xffff0000, v250
    v_mul_f32 v242, 0x3fb8aa3b, v242
    v_mul_f32 v243, 0x3fb8aa3b, v243
    v_cvt_pk_bf16_f32 v250, v244, v245
    v_lshlrev_b32 v244, 16, v250
    v_and_b32 v245, 0xffff0000, v250
    v_mul_f32 v244, 0x3d93cd3a, v244
    v_mul_f32 v245, 0x3d93cd3a, v245
    v_cvt_pk_bf16_f32 v250, v244, v245
    v_lshlrev_b32 v244, 16, v250
    v_and_b32 v245, 0xffff0000, v250
    v_mul_f32 v244, 0x3fb8aa3b, v244
    v_mul_f32 v245, 0x3fb8aa3b, v245
    v_cvt_pk_bf16_f32 v250, v246, v247
    v_lshlrev_b32 v246, 16, v250
    v_and_b32 v247, 0xffff0000, v250
    v_mul_f32 v246, 0x3d93cd3a, v246
    v_mul_f32 v247, 0x3d93cd3a, v247
    v_cvt_pk_bf16_f32 v250, v246, v247
    v_lshlrev_b32 v246, 16, v250
    v_and_b32 v247, 0xffff0000, v250
    v_mul_f32 v246, 0x3fb8aa3b, v246
    v_mul_f32 v247, 0x3fb8aa3b, v247
    v_max_f32 v250, v248, v240
    v_max3_f32 v250, v250, v241, v242
    v_max3_f32 v250, v250, v243, v244
    v_max3_f32 v250, v250, v245, v246
    v_max_f32 v250, v250, v247
    v_sub_f32 v251, v248, v250
    v_exp_f32 v251, v251
    v_mov_b32 v248, v250
    v_sub_f32 v240, v240, v250
    v_exp_f32 v240, v240
    v_sub_f32 v241, v241, v250
    v_exp_f32 v241, v241
    v_sub_f32 v242, v242, v250
    v_exp_f32 v242, v242
    v_sub_f32 v243, v243, v250
    v_exp_f32 v243, v243
    v_sub_f32 v244, v244, v250
    v_exp_f32 v244, v244
    v_sub_f32 v245, v245, v250
    v_exp_f32 v245, v245
    v_sub_f32 v246, v246, v250
    v_exp_f32 v246, v246
    v_sub_f32 v247, v247, v250
    v_exp_f32 v247, v247
    v_mul_f32 v249, v249, v251
    v_mul_f32 v216, v216, v251
    v_mul_f32 v217, v217, v251
    v_mul_f32 v218, v218, v251
    v_mul_f32 v219, v219, v251
    v_mul_f32 v220, v220, v251
    v_mul_f32 v221, v221, v251
    v_mul_f32 v222, v222, v251
    v_mul_f32 v223, v223, v251
    v_mul_f32 v224, v224, v251
    v_mul_f32 v225, v225, v251
    v_mul_f32 v226, v226, v251
    v_mul_f32 v227, v227, v251
    v_mul_f32 v228, v228, v251
    v_mul_f32 v229, v229, v251
    v_mul_f32 v230, v230, v251
    v_mul_f32 v231, v231, v251
    v_mul_f32 v232, v232, v251
    v_mul_f32 v233, v233, v251
    v_mul_f32 v234, v234, v251
    v_mul_f32 v235, v235, v251
    v_mul_f32 v236, v236, v251
    v_mul_f32 v237, v237, v251
    v_mul_f32 v238, v238, v251
    v_mul_f32 v239, v239, v251
    v_add_f32 v249, v249, v240
    v_add_f32 v249, v249, v241
    v_add_f32 v249, v249, v242
    v_add_f32 v249, v249, v243
    v_add_f32 v249, v249, v244
    v_add_f32 v249, v249, v245
    v_add_f32 v249, v249, v246
    v_add_f32 v249, v249, v247
    s_cmp_eq_u32 s33, 0
    s_cbranch_scc1 L_at_waitV0
    s_waitcnt vmcnt(24)
    s_branch L_at_waitV1
L_at_waitV0:
    s_waitcnt vmcnt(0)
L_at_waitV1:
    v_lshlrev_b32 v250, 16, v120
    v_and_b32 v251, 0xffff0000, v120
    v_fmac_f32 v216, v240, v250
    v_fmac_f32 v217, v240, v251
    v_lshlrev_b32 v252, 16, v121
    v_and_b32 v253, 0xffff0000, v121
    v_fmac_f32 v218, v240, v252
    v_fmac_f32 v219, v240, v253
    v_lshlrev_b32 v250, 16, v122
    v_and_b32 v251, 0xffff0000, v122
    v_fmac_f32 v220, v240, v250
    v_fmac_f32 v221, v240, v251
    v_lshlrev_b32 v252, 16, v123
    v_and_b32 v253, 0xffff0000, v123
    v_fmac_f32 v222, v240, v252
    v_fmac_f32 v223, v240, v253
    v_lshlrev_b32 v250, 16, v124
    v_and_b32 v251, 0xffff0000, v124
    v_fmac_f32 v224, v240, v250
    v_fmac_f32 v225, v240, v251
    v_lshlrev_b32 v252, 16, v125
    v_and_b32 v253, 0xffff0000, v125
    v_fmac_f32 v226, v240, v252
    v_fmac_f32 v227, v240, v253
    v_lshlrev_b32 v250, 16, v126
    v_and_b32 v251, 0xffff0000, v126
    v_fmac_f32 v228, v240, v250
    v_fmac_f32 v229, v240, v251
    v_lshlrev_b32 v252, 16, v127
    v_and_b32 v253, 0xffff0000, v127
    v_fmac_f32 v230, v240, v252
    v_fmac_f32 v231, v240, v253
    v_lshlrev_b32 v250, 16, v128
    v_and_b32 v251, 0xffff0000, v128
    v_fmac_f32 v232, v240, v250
    v_fmac_f32 v233, v240, v251
    v_lshlrev_b32 v252, 16, v129
    v_and_b32 v253, 0xffff0000, v129
    v_fmac_f32 v234, v240, v252
    v_fmac_f32 v235, v240, v253
    v_lshlrev_b32 v250, 16, v130
    v_and_b32 v251, 0xffff0000, v130
    v_fmac_f32 v236, v240, v250
    v_fmac_f32 v237, v240, v251
    v_lshlrev_b32 v252, 16, v131
    v_and_b32 v253, 0xffff0000, v131
    v_fmac_f32 v238, v240, v252
    v_fmac_f32 v239, v240, v253
    v_lshlrev_b32 v250, 16, v132
    v_and_b32 v251, 0xffff0000, v132
    v_fmac_f32 v216, v241, v250
    v_fmac_f32 v217, v241, v251
    v_lshlrev_b32 v252, 16, v133
    v_and_b32 v253, 0xffff0000, v133
    v_fmac_f32 v218, v241, v252
    v_fmac_f32 v219, v241, v253
    v_lshlrev_b32 v250, 16, v134
    v_and_b32 v251, 0xffff0000, v134
    v_fmac_f32 v220, v241, v250
    v_fmac_f32 v221, v241, v251
    v_lshlrev_b32 v252, 16, v135
    v_and_b32 v253, 0xffff0000, v135
    v_fmac_f32 v222, v241, v252
    v_fmac_f32 v223, v241, v253
    v_lshlrev_b32 v250, 16, v136
    v_and_b32 v251, 0xffff0000, v136
    v_fmac_f32 v224, v241, v250
    v_fmac_f32 v225, v241, v251
    v_lshlrev_b32 v252, 16, v137
    v_and_b32 v253, 0xffff0000, v137
    v_fmac_f32 v226, v241, v252
    v_fmac_f32 v227, v241, v253
    v_lshlrev_b32 v250, 16, v138
    v_and_b32 v251, 0xffff0000, v138
    v_fmac_f32 v228, v241, v250
    v_fmac_f32 v229, v241, v251
    v_lshlrev_b32 v252, 16, v139
    v_and_b32 v253, 0xffff0000, v139
    v_fmac_f32 v230, v241, v252
    v_fmac_f32 v231, v241, v253
    v_lshlrev_b32 v250, 16, v140
    v_and_b32 v251, 0xffff0000, v140
    v_fmac_f32 v232, v241, v250
    v_fmac_f32 v233, v241, v251
    v_lshlrev_b32 v252, 16, v141
    v_and_b32 v253, 0xffff0000, v141
    v_fmac_f32 v234, v241, v252
    v_fmac_f32 v235, v241, v253
    v_lshlrev_b32 v250, 16, v142
    v_and_b32 v251, 0xffff0000, v142
    v_fmac_f32 v236, v241, v250
    v_fmac_f32 v237, v241, v251
    v_lshlrev_b32 v252, 16, v143
    v_and_b32 v253, 0xffff0000, v143
    v_fmac_f32 v238, v241, v252
    v_fmac_f32 v239, v241, v253
    v_lshlrev_b32 v250, 16, v144
    v_and_b32 v251, 0xffff0000, v144
    v_fmac_f32 v216, v242, v250
    v_fmac_f32 v217, v242, v251
    v_lshlrev_b32 v252, 16, v145
    v_and_b32 v253, 0xffff0000, v145
    v_fmac_f32 v218, v242, v252
    v_fmac_f32 v219, v242, v253
    v_lshlrev_b32 v250, 16, v146
    v_and_b32 v251, 0xffff0000, v146
    v_fmac_f32 v220, v242, v250
    v_fmac_f32 v221, v242, v251
    v_lshlrev_b32 v252, 16, v147
    v_and_b32 v253, 0xffff0000, v147
    v_fmac_f32 v222, v242, v252
    v_fmac_f32 v223, v242, v253
    v_lshlrev_b32 v250, 16, v148
    v_and_b32 v251, 0xffff0000, v148
    v_fmac_f32 v224, v242, v250
    v_fmac_f32 v225, v242, v251
    v_lshlrev_b32 v252, 16, v149
    v_and_b32 v253, 0xffff0000, v149
    v_fmac_f32 v226, v242, v252
    v_fmac_f32 v227, v242, v253
    v_lshlrev_b32 v250, 16, v150
    v_and_b32 v251, 0xffff0000, v150
    v_fmac_f32 v228, v242, v250
    v_fmac_f32 v229, v242, v251
    v_lshlrev_b32 v252, 16, v151
    v_and_b32 v253, 0xffff0000, v151
    v_fmac_f32 v230, v242, v252
    v_fmac_f32 v231, v242, v253
    v_lshlrev_b32 v250, 16, v152
    v_and_b32 v251, 0xffff0000, v152
    v_fmac_f32 v232, v242, v250
    v_fmac_f32 v233, v242, v251
    v_lshlrev_b32 v252, 16, v153
    v_and_b32 v253, 0xffff0000, v153
    v_fmac_f32 v234, v242, v252
    v_fmac_f32 v235, v242, v253
    v_lshlrev_b32 v250, 16, v154
    v_and_b32 v251, 0xffff0000, v154
    v_fmac_f32 v236, v242, v250
    v_fmac_f32 v237, v242, v251
    v_lshlrev_b32 v252, 16, v155
    v_and_b32 v253, 0xffff0000, v155
    v_fmac_f32 v238, v242, v252
    v_fmac_f32 v239, v242, v253
    v_lshlrev_b32 v250, 16, v156
    v_and_b32 v251, 0xffff0000, v156
    v_fmac_f32 v216, v243, v250
    v_fmac_f32 v217, v243, v251
    v_lshlrev_b32 v252, 16, v157
    v_and_b32 v253, 0xffff0000, v157
    v_fmac_f32 v218, v243, v252
    v_fmac_f32 v219, v243, v253
    v_lshlrev_b32 v250, 16, v158
    v_and_b32 v251, 0xffff0000, v158
    v_fmac_f32 v220, v243, v250
    v_fmac_f32 v221, v243, v251
    v_lshlrev_b32 v252, 16, v159
    v_and_b32 v253, 0xffff0000, v159
    v_fmac_f32 v222, v243, v252
    v_fmac_f32 v223, v243, v253
    v_lshlrev_b32 v250, 16, v160
    v_and_b32 v251, 0xffff0000, v160
    v_fmac_f32 v224, v243, v250
    v_fmac_f32 v225, v243, v251
    v_lshlrev_b32 v252, 16, v161
    v_and_b32 v253, 0xffff0000, v161
    v_fmac_f32 v226, v243, v252
    v_fmac_f32 v227, v243, v253
    v_lshlrev_b32 v250, 16, v162
    v_and_b32 v251, 0xffff0000, v162
    v_fmac_f32 v228, v243, v250
    v_fmac_f32 v229, v243, v251
    v_lshlrev_b32 v252, 16, v163
    v_and_b32 v253, 0xffff0000, v163
    v_fmac_f32 v230, v243, v252
    v_fmac_f32 v231, v243, v253
    v_lshlrev_b32 v250, 16, v164
    v_and_b32 v251, 0xffff0000, v164
    v_fmac_f32 v232, v243, v250
    v_fmac_f32 v233, v243, v251
    v_lshlrev_b32 v252, 16, v165
    v_and_b32 v253, 0xffff0000, v165
    v_fmac_f32 v234, v243, v252
    v_fmac_f32 v235, v243, v253
    v_lshlrev_b32 v250, 16, v166
    v_and_b32 v251, 0xffff0000, v166
    v_fmac_f32 v236, v243, v250
    v_fmac_f32 v237, v243, v251
    v_lshlrev_b32 v252, 16, v167
    v_and_b32 v253, 0xffff0000, v167
    v_fmac_f32 v238, v243, v252
    v_fmac_f32 v239, v243, v253
    v_lshlrev_b32 v250, 16, v168
    v_and_b32 v251, 0xffff0000, v168
    v_fmac_f32 v216, v244, v250
    v_fmac_f32 v217, v244, v251
    v_lshlrev_b32 v252, 16, v169
    v_and_b32 v253, 0xffff0000, v169
    v_fmac_f32 v218, v244, v252
    v_fmac_f32 v219, v244, v253
    v_lshlrev_b32 v250, 16, v170
    v_and_b32 v251, 0xffff0000, v170
    v_fmac_f32 v220, v244, v250
    v_fmac_f32 v221, v244, v251
    v_lshlrev_b32 v252, 16, v171
    v_and_b32 v253, 0xffff0000, v171
    v_fmac_f32 v222, v244, v252
    v_fmac_f32 v223, v244, v253
    v_lshlrev_b32 v250, 16, v172
    v_and_b32 v251, 0xffff0000, v172
    v_fmac_f32 v224, v244, v250
    v_fmac_f32 v225, v244, v251
    v_lshlrev_b32 v252, 16, v173
    v_and_b32 v253, 0xffff0000, v173
    v_fmac_f32 v226, v244, v252
    v_fmac_f32 v227, v244, v253
    v_lshlrev_b32 v250, 16, v174
    v_and_b32 v251, 0xffff0000, v174
    v_fmac_f32 v228, v244, v250
    v_fmac_f32 v229, v244, v251
    v_lshlrev_b32 v252, 16, v175
    v_and_b32 v253, 0xffff0000, v175
    v_fmac_f32 v230, v244, v252
    v_fmac_f32 v231, v244, v253
    v_lshlrev_b32 v250, 16, v176
    v_and_b32 v251, 0xffff0000, v176
    v_fmac_f32 v232, v244, v250
    v_fmac_f32 v233, v244, v251
    v_lshlrev_b32 v252, 16, v177
    v_and_b32 v253, 0xffff0000, v177
    v_fmac_f32 v234, v244, v252
    v_fmac_f32 v235, v244, v253
    v_lshlrev_b32 v250, 16, v178
    v_and_b32 v251, 0xffff0000, v178
    v_fmac_f32 v236, v244, v250
    v_fmac_f32 v237, v244, v251
    v_lshlrev_b32 v252, 16, v179
    v_and_b32 v253, 0xffff0000, v179
    v_fmac_f32 v238, v244, v252
    v_fmac_f32 v239, v244, v253
    v_lshlrev_b32 v250, 16, v180
    v_and_b32 v251, 0xffff0000, v180
    v_fmac_f32 v216, v245, v250
    v_fmac_f32 v217, v245, v251
    v_lshlrev_b32 v252, 16, v181
    v_and_b32 v253, 0xffff0000, v181
    v_fmac_f32 v218, v245, v252
    v_fmac_f32 v219, v245, v253
    v_lshlrev_b32 v250, 16, v182
    v_and_b32 v251, 0xffff0000, v182
    v_fmac_f32 v220, v245, v250
    v_fmac_f32 v221, v245, v251
    v_lshlrev_b32 v252, 16, v183
    v_and_b32 v253, 0xffff0000, v183
    v_fmac_f32 v222, v245, v252
    v_fmac_f32 v223, v245, v253
    v_lshlrev_b32 v250, 16, v184
    v_and_b32 v251, 0xffff0000, v184
    v_fmac_f32 v224, v245, v250
    v_fmac_f32 v225, v245, v251
    v_lshlrev_b32 v252, 16, v185
    v_and_b32 v253, 0xffff0000, v185
    v_fmac_f32 v226, v245, v252
    v_fmac_f32 v227, v245, v253
    v_lshlrev_b32 v250, 16, v186
    v_and_b32 v251, 0xffff0000, v186
    v_fmac_f32 v228, v245, v250
    v_fmac_f32 v229, v245, v251
    v_lshlrev_b32 v252, 16, v187
    v_and_b32 v253, 0xffff0000, v187
    v_fmac_f32 v230, v245, v252
    v_fmac_f32 v231, v245, v253
    v_lshlrev_b32 v250, 16, v188
    v_and_b32 v251, 0xffff0000, v188
    v_fmac_f32 v232, v245, v250
    v_fmac_f32 v233, v245, v251
    v_lshlrev_b32 v252, 16, v189
    v_and_b32 v253, 0xffff0000, v189
    v_fmac_f32 v234, v245, v252
    v_fmac_f32 v235, v245, v253
    v_lshlrev_b32 v250, 16, v190
    v_and_b32 v251, 0xffff0000, v190
    v_fmac_f32 v236, v245, v250
    v_fmac_f32 v237, v245, v251
    v_lshlrev_b32 v252, 16, v191
    v_and_b32 v253, 0xffff0000, v191
    v_fmac_f32 v238, v245, v252
    v_fmac_f32 v239, v245, v253
    v_lshlrev_b32 v250, 16, v192
    v_and_b32 v251, 0xffff0000, v192
    v_fmac_f32 v216, v246, v250
    v_fmac_f32 v217, v246, v251
    v_lshlrev_b32 v252, 16, v193
    v_and_b32 v253, 0xffff0000, v193
    v_fmac_f32 v218, v246, v252
    v_fmac_f32 v219, v246, v253
    v_lshlrev_b32 v250, 16, v194
    v_and_b32 v251, 0xffff0000, v194
    v_fmac_f32 v220, v246, v250
    v_fmac_f32 v221, v246, v251
    v_lshlrev_b32 v252, 16, v195
    v_and_b32 v253, 0xffff0000, v195
    v_fmac_f32 v222, v246, v252
    v_fmac_f32 v223, v246, v253
    v_lshlrev_b32 v250, 16, v196
    v_and_b32 v251, 0xffff0000, v196
    v_fmac_f32 v224, v246, v250
    v_fmac_f32 v225, v246, v251
    v_lshlrev_b32 v252, 16, v197
    v_and_b32 v253, 0xffff0000, v197
    v_fmac_f32 v226, v246, v252
    v_fmac_f32 v227, v246, v253
    v_lshlrev_b32 v250, 16, v198
    v_and_b32 v251, 0xffff0000, v198
    v_fmac_f32 v228, v246, v250
    v_fmac_f32 v229, v246, v251
    v_lshlrev_b32 v252, 16, v199
    v_and_b32 v253, 0xffff0000, v199
    v_fmac_f32 v230, v246, v252
    v_fmac_f32 v231, v246, v253
    v_lshlrev_b32 v250, 16, v200
    v_and_b32 v251, 0xffff0000, v200
    v_fmac_f32 v232, v246, v250
    v_fmac_f32 v233, v246, v251
    v_lshlrev_b32 v252, 16, v201
    v_and_b32 v253, 0xffff0000, v201
    v_fmac_f32 v234, v246, v252
    v_fmac_f32 v235, v246, v253
    v_lshlrev_b32 v250, 16, v202
    v_and_b32 v251, 0xffff0000, v202
    v_fmac_f32 v236, v246, v250
    v_fmac_f32 v237, v246, v251
    v_lshlrev_b32 v252, 16, v203
    v_and_b32 v253, 0xffff0000, v203
    v_fmac_f32 v238, v246, v252
    v_fmac_f32 v239, v246, v253
    v_lshlrev_b32 v250, 16, v204
    v_and_b32 v251, 0xffff0000, v204
    v_fmac_f32 v216, v247, v250
    v_fmac_f32 v217, v247, v251
    v_lshlrev_b32 v252, 16, v205
    v_and_b32 v253, 0xffff0000, v205
    v_fmac_f32 v218, v247, v252
    v_fmac_f32 v219, v247, v253
    v_lshlrev_b32 v250, 16, v206
    v_and_b32 v251, 0xffff0000, v206
    v_fmac_f32 v220, v247, v250
    v_fmac_f32 v221, v247, v251
    v_lshlrev_b32 v252, 16, v207
    v_and_b32 v253, 0xffff0000, v207
    v_fmac_f32 v222, v247, v252
    v_fmac_f32 v223, v247, v253
    v_lshlrev_b32 v250, 16, v208
    v_and_b32 v251, 0xffff0000, v208
    v_fmac_f32 v224, v247, v250
    v_fmac_f32 v225, v247, v251
    v_lshlrev_b32 v252, 16, v209
    v_and_b32 v253, 0xffff0000, v209
    v_fmac_f32 v226, v247, v252
    v_fmac_f32 v227, v247, v253
    v_lshlrev_b32 v250, 16, v210
    v_and_b32 v251, 0xffff0000, v210
    v_fmac_f32 v228, v247, v250
    v_fmac_f32 v229, v247, v251
    v_lshlrev_b32 v252, 16, v211
    v_and_b32 v253, 0xffff0000, v211
    v_fmac_f32 v230, v247, v252
    v_fmac_f32 v231, v247, v253
    v_lshlrev_b32 v250, 16, v212
    v_and_b32 v251, 0xffff0000, v212
    v_fmac_f32 v232, v247, v250
    v_fmac_f32 v233, v247, v251
    v_lshlrev_b32 v252, 16, v213
    v_and_b32 v253, 0xffff0000, v213
    v_fmac_f32 v234, v247, v252
    v_fmac_f32 v235, v247, v253
    v_lshlrev_b32 v250, 16, v214
    v_and_b32 v251, 0xffff0000, v214
    v_fmac_f32 v236, v247, v250
    v_fmac_f32 v237, v247, v251
    v_lshlrev_b32 v252, 16, v215
    v_and_b32 v253, 0xffff0000, v215
    v_fmac_f32 v238, v247, v252
    v_fmac_f32 v239, v247, v253
    s_cmp_eq_u32 s33, 0
    s_cbranch_scc1 L_at_done
    s_add_u32 s36, s36, 24576
    s_add_u32 s37, s37, 24576
    s_add_u32 s38, s38, 24576
    s_add_u32 s39, s39, 24576
    s_add_u32 s40, s40, 24576
    s_add_u32 s41, s41, 24576
    s_add_u32 s42, s42, 24576
    s_add_u32 s43, s43, 24576
    buffer_load_dwordx4 v[120:123], v5, s[16:19], s36 offen offset:0 nt
    buffer_load_dwordx4 v[124:127], v5, s[16:19], s36 offen offset:128 nt
    buffer_load_dwordx4 v[128:131], v5, s[16:19], s36 offen offset:256 nt
    buffer_load_dwordx4 v[132:135], v5, s[16:19], s37 offen offset:0 nt
    buffer_load_dwordx4 v[136:139], v5, s[16:19], s37 offen offset:128 nt
    buffer_load_dwordx4 v[140:143], v5, s[16:19], s37 offen offset:256 nt
    buffer_load_dwordx4 v[144:147], v5, s[16:19], s38 offen offset:0 nt
    buffer_load_dwordx4 v[148:151], v5, s[16:19], s38 offen offset:128 nt
    buffer_load_dwordx4 v[152:155], v5, s[16:19], s38 offen offset:256 nt
    buffer_load_dwordx4 v[156:159], v5, s[16:19], s39 offen offset:0 nt
    buffer_load_dwordx4 v[160:163], v5, s[16:19], s39 offen offset:128 nt
    buffer_load_dwordx4 v[164:167], v5, s[16:19], s39 offen offset:256 nt
    buffer_load_dwordx4 v[168:171], v5, s[16:19], s40 offen offset:0 nt
    buffer_load_dwordx4 v[172:175], v5, s[16:19], s40 offen offset:128 nt
    buffer_load_dwordx4 v[176:179], v5, s[16:19], s40 offen offset:256 nt
    buffer_load_dwordx4 v[180:183], v5, s[16:19], s41 offen offset:0 nt
    buffer_load_dwordx4 v[184:187], v5, s[16:19], s41 offen offset:128 nt
    buffer_load_dwordx4 v[188:191], v5, s[16:19], s41 offen offset:256 nt
    buffer_load_dwordx4 v[192:195], v5, s[16:19], s42 offen offset:0 nt
    buffer_load_dwordx4 v[196:199], v5, s[16:19], s42 offen offset:128 nt
    buffer_load_dwordx4 v[200:203], v5, s[16:19], s42 offen offset:256 nt
    buffer_load_dwordx4 v[204:207], v5, s[16:19], s43 offen offset:0 nt
    buffer_load_dwordx4 v[208:211], v5, s[16:19], s43 offen offset:128 nt
    buffer_load_dwordx4 v[212:215], v5, s[16:19], s43 offen offset:256 nt
    s_branch L_at_loop
L_at_done:
    s_barrier
    v_lshrrev_b32 v6, 3, v0
    v_mul_u32_u24 v7, 768, v6
    v_lshlrev_b32 v8, 5, v2
    v_add_u32 v7, v7, v8
    ds_write_b128 v7, v[216:219] offset:512
    ds_write_b128 v7, v[220:223] offset:528
    ds_write_b128 v7, v[224:227] offset:768
    ds_write_b128 v7, v[228:231] offset:784
    ds_write_b128 v7, v[232:235] offset:1024
    ds_write_b128 v7, v[236:239] offset:1040
    v_lshlrev_b32 v8, 2, v6
    ds_write_b32 v8, v248
    ds_write_b32 v8, v249 offset:128
    s_waitcnt lgkmcnt(0)
    s_barrier
    v_cmp_gt_u32 vcc, 192, v0
    s_and_saveexec_b64 s[26:27], vcc
    s_cbranch_execz L_at_fin
    v_mov_b32 v1, 0
    ds_read_b128 v[24:27], v1 offset:0
    ds_read_b128 v[56:59], v1 offset:128
    ds_read_b128 v[28:31], v1 offset:16
    ds_read_b128 v[60:63], v1 offset:144
    ds_read_b128 v[32:35], v1 offset:32
    ds_read_b128 v[64:67], v1 offset:160
    ds_read_b128 v[36:39], v1 offset:48
    ds_read_b128 v[68:71], v1 offset:176
    ds_read_b128 v[40:43], v1 offset:64
    ds_read_b128 v[72:75], v1 offset:192
    ds_read_b128 v[44:47], v1 offset:80
    ds_read_b128 v[76:79], v1 offset:208
    ds_read_b128 v[48:51], v1 offset:96
    ds_read_b128 v[80:83], v1 offset:224
    ds_read_b128 v[52:55], v1 offset:112
    ds_read_b128 v[84:87], v1 offset:240
    s_waitcnt lgkmcnt(0)
    v_max_f32 v2, v24, v25
    v_max3_f32 v2, v2, v26, v27
    v_max3_f32 v2, v2, v28, v29
    v_max3_f32 v2, v2, v30, v31
    v_max3_f32 v2, v2, v32, v33
    v_max3_f32 v2, v2, v34, v35
    v_max3_f32 v2, v2, v36, v37
    v_max3_f32 v2, v2, v38, v39
    v_max3_f32 v2, v2, v40, v41
    v_max3_f32 v2, v2, v42, v43
    v_max3_f32 v2, v2, v44, v45
    v_max3_f32 v2, v2, v46, v47
    v_max3_f32 v2, v2, v48, v49
    v_max3_f32 v2, v2, v50, v51
    v_max3_f32 v2, v2, v52, v53
    v_max3_f32 v2, v2, v54, v55
    v_sub_f32 v24, v24, v2
    v_exp_f32 v24, v24
    v_sub_f32 v25, v25, v2
    v_exp_f32 v25, v25
    v_sub_f32 v26, v26, v2
    v_exp_f32 v26, v26
    v_sub_f32 v27, v27, v2
    v_exp_f32 v27, v27
    v_sub_f32 v28, v28, v2
    v_exp_f32 v28, v28
    v_sub_f32 v29, v29, v2
    v_exp_f32 v29, v29
    v_sub_f32 v30, v30, v2
    v_exp_f32 v30, v30
    v_sub_f32 v31, v31, v2
    v_exp_f32 v31, v31
    v_sub_f32 v32, v32, v2
    v_exp_f32 v32, v32
    v_sub_f32 v33, v33, v2
    v_exp_f32 v33, v33
    v_sub_f32 v34, v34, v2
    v_exp_f32 v34, v34
    v_sub_f32 v35, v35, v2
    v_exp_f32 v35, v35
    v_sub_f32 v36, v36, v2
    v_exp_f32 v36, v36
    v_sub_f32 v37, v37, v2
    v_exp_f32 v37, v37
    v_sub_f32 v38, v38, v2
    v_exp_f32 v38, v38
    v_sub_f32 v39, v39, v2
    v_exp_f32 v39, v39
    v_sub_f32 v40, v40, v2
    v_exp_f32 v40, v40
    v_sub_f32 v41, v41, v2
    v_exp_f32 v41, v41
    v_sub_f32 v42, v42, v2
    v_exp_f32 v42, v42
    v_sub_f32 v43, v43, v2
    v_exp_f32 v43, v43
    v_sub_f32 v44, v44, v2
    v_exp_f32 v44, v44
    v_sub_f32 v45, v45, v2
    v_exp_f32 v45, v45
    v_sub_f32 v46, v46, v2
    v_exp_f32 v46, v46
    v_sub_f32 v47, v47, v2
    v_exp_f32 v47, v47
    v_sub_f32 v48, v48, v2
    v_exp_f32 v48, v48
    v_sub_f32 v49, v49, v2
    v_exp_f32 v49, v49
    v_sub_f32 v50, v50, v2
    v_exp_f32 v50, v50
    v_sub_f32 v51, v51, v2
    v_exp_f32 v51, v51
    v_sub_f32 v52, v52, v2
    v_exp_f32 v52, v52
    v_sub_f32 v53, v53, v2
    v_exp_f32 v53, v53
    v_sub_f32 v54, v54, v2
    v_exp_f32 v54, v54
    v_sub_f32 v55, v55, v2
    v_exp_f32 v55, v55
    v_mul_f32 v3, v24, v56
    v_fmac_f32 v3, v25, v57
    v_fmac_f32 v3, v26, v58
    v_fmac_f32 v3, v27, v59
    v_fmac_f32 v3, v28, v60
    v_fmac_f32 v3, v29, v61
    v_fmac_f32 v3, v30, v62
    v_fmac_f32 v3, v31, v63
    v_fmac_f32 v3, v32, v64
    v_fmac_f32 v3, v33, v65
    v_fmac_f32 v3, v34, v66
    v_fmac_f32 v3, v35, v67
    v_fmac_f32 v3, v36, v68
    v_fmac_f32 v3, v37, v69
    v_fmac_f32 v3, v38, v70
    v_fmac_f32 v3, v39, v71
    v_fmac_f32 v3, v40, v72
    v_fmac_f32 v3, v41, v73
    v_fmac_f32 v3, v42, v74
    v_fmac_f32 v3, v43, v75
    v_fmac_f32 v3, v44, v76
    v_fmac_f32 v3, v45, v77
    v_fmac_f32 v3, v46, v78
    v_fmac_f32 v3, v47, v79
    v_fmac_f32 v3, v48, v80
    v_fmac_f32 v3, v49, v81
    v_fmac_f32 v3, v50, v82
    v_fmac_f32 v3, v51, v83
    v_fmac_f32 v3, v52, v84
    v_fmac_f32 v3, v53, v85
    v_fmac_f32 v3, v54, v86
    v_fmac_f32 v3, v55, v87
    v_lshlrev_b32 v4, 2, v0
    ds_read_b32 v56, v4 offset:512
    ds_read_b32 v57, v4 offset:1280
    ds_read_b32 v58, v4 offset:2048
    ds_read_b32 v59, v4 offset:2816
    ds_read_b32 v60, v4 offset:3584
    ds_read_b32 v61, v4 offset:4352
    ds_read_b32 v62, v4 offset:5120
    ds_read_b32 v63, v4 offset:5888
    ds_read_b32 v64, v4 offset:6656
    ds_read_b32 v65, v4 offset:7424
    ds_read_b32 v66, v4 offset:8192
    ds_read_b32 v67, v4 offset:8960
    ds_read_b32 v68, v4 offset:9728
    ds_read_b32 v69, v4 offset:10496
    ds_read_b32 v70, v4 offset:11264
    ds_read_b32 v71, v4 offset:12032
    ds_read_b32 v72, v4 offset:12800
    ds_read_b32 v73, v4 offset:13568
    ds_read_b32 v74, v4 offset:14336
    ds_read_b32 v75, v4 offset:15104
    ds_read_b32 v76, v4 offset:15872
    ds_read_b32 v77, v4 offset:16640
    ds_read_b32 v78, v4 offset:17408
    ds_read_b32 v79, v4 offset:18176
    ds_read_b32 v80, v4 offset:18944
    ds_read_b32 v81, v4 offset:19712
    ds_read_b32 v82, v4 offset:20480
    ds_read_b32 v83, v4 offset:21248
    ds_read_b32 v84, v4 offset:22016
    ds_read_b32 v85, v4 offset:22784
    ds_read_b32 v86, v4 offset:23552
    ds_read_b32 v87, v4 offset:24320
    s_waitcnt lgkmcnt(0)
    v_mul_f32 v5, v24, v56
    v_fmac_f32 v5, v25, v57
    v_fmac_f32 v5, v26, v58
    v_fmac_f32 v5, v27, v59
    v_fmac_f32 v5, v28, v60
    v_fmac_f32 v5, v29, v61
    v_fmac_f32 v5, v30, v62
    v_fmac_f32 v5, v31, v63
    v_fmac_f32 v5, v32, v64
    v_fmac_f32 v5, v33, v65
    v_fmac_f32 v5, v34, v66
    v_fmac_f32 v5, v35, v67
    v_fmac_f32 v5, v36, v68
    v_fmac_f32 v5, v37, v69
    v_fmac_f32 v5, v38, v70
    v_fmac_f32 v5, v39, v71
    v_fmac_f32 v5, v40, v72
    v_fmac_f32 v5, v41, v73
    v_fmac_f32 v5, v42, v74
    v_fmac_f32 v5, v43, v75
    v_fmac_f32 v5, v44, v76
    v_fmac_f32 v5, v45, v77
    v_fmac_f32 v5, v46, v78
    v_fmac_f32 v5, v47, v79
    v_fmac_f32 v5, v48, v80
    v_fmac_f32 v5, v49, v81
    v_fmac_f32 v5, v50, v82
    v_fmac_f32 v5, v51, v83
    v_fmac_f32 v5, v52, v84
    v_fmac_f32 v5, v53, v85
    v_fmac_f32 v5, v54, v86
    v_fmac_f32 v5, v55, v87
    s_mul_i32 s28, s2, 768
    s_add_u32 s28, s28, 360448
    buffer_store_dword v5, v4, s[20:23], s28 offen
    v_cmp_eq_u32 vcc, 0, v0
    s_and_saveexec_b64 s[34:35], vcc
    s_cbranch_execz L_at_fin
    s_lshl_b32 s28, s2, 3
    s_add_u32 s28, s28, 294912
    buffer_store_dwordx2 v[2:3], v1, s[20:23], s28 offen
L_at_fin:
L_at_end:
    s_endpgm
.globl comb_kernel
.p2align 8
.type comb_kernel,@function
comb_kernel:
    s_cmp_ge_u32 s2, 160
    s_cbranch_scc1 L_cb_end
    s_load_dwordx2 s[4:5], s[0:1], 32
    s_load_dwordx2 s[6:7], s[0:1], 64
    s_load_dwordx2 s[8:9], s[0:1], 88
    s_waitcnt lgkmcnt(0)
    s_mov_b32 s20, s8
    s_mov_b32 s21, s9
    s_mov_b32 s22, 4964352
    s_mov_b32 s23, 0x00020000
    v_and_b32 v1, 63, v0
    v_lshlrev_b32 v30, 2, v1
    s_cmp_lt_u32 s2, 128
    s_cbranch_scc0 L_cb_Bsel
    s_mov_b32 s12, s4
    s_mov_b32 s13, s5
    s_mov_b32 s14, 7864320
    s_mov_b32 s15, 0x00020000
    s_lshr_b32 s24, s2, 2
    s_and_b32 s25, s2, 3
    s_mul_i32 s26, s24, 192
    s_mul_i32 s27, s25, 48
    s_add_u32 s26, s26, s27
    s_branch L_cb_sel
L_cb_Bsel:
    s_mov_b32 s12, s6
    s_mov_b32 s13, s7
    s_mov_b32 s14, 1966080
    s_mov_b32 s15, 0x00020000
    s_sub_u32 s24, s2, 128
    s_mul_i32 s26, s24, 48
L_cb_sel:
    v_cmp_gt_u32 vcc, 240, v0
    s_and_saveexec_b64 s[30:31], vcc
    v_mul_u32_u24 v2, 820, v0
    v_lshrrev_b32 v2, 16, v2
    v_mul_u32_u24 v3, 80, v2
    v_sub_u32 v3, v0, v3
    v_mul_u32_u24 v5, 20480, v2
    v_lshl_add_u32 v5, v3, 4, v5
    s_mul_i32 s33, s26, 1280
    buffer_load_dwordx4 v[64:67], v5, s[12:15], s33 offen
    s_add_u32 s33, s33, 1280
    buffer_load_dwordx4 v[68:71], v5, s[12:15], s33 offen
    s_add_u32 s33, s33, 1280
    buffer_load_dwordx4 v[72:75], v5, s[12:15], s33 offen
    s_add_u32 s33, s33, 1280
    buffer_load_dwordx4 v[76:79], v5, s[12:15], s33 offen
    s_add_u32 s33, s33, 1280
    buffer_load_dwordx4 v[80:83], v5, s[12:15], s33 offen
    s_add_u32 s33, s33, 1280
    buffer_load_dwordx4 v[84:87], v5, s[12:15], s33 offen
    s_add_u32 s33, s33, 1280
    buffer_load_dwordx4 v[88:91], v5, s[12:15], s33 offen
    s_add_u32 s33, s33, 1280
    buffer_load_dwordx4 v[92:95], v5, s[12:15], s33 offen
    s_add_u32 s33, s33, 1280
    buffer_load_dwordx4 v[96:99], v5, s[12:15], s33 offen
    s_add_u32 s33, s33, 1280
    buffer_load_dwordx4 v[100:103], v5, s[12:15], s33 offen
    s_add_u32 s33, s33, 1280
    buffer_load_dwordx4 v[104:107], v5, s[12:15], s33 offen
    s_add_u32 s33, s33, 1280
    buffer_load_dwordx4 v[108:111], v5, s[12:15], s33 offen
    s_add_u32 s33, s33, 1280
    buffer_load_dwordx4 v[112:115], v5, s[12:15], s33 offen
    s_add_u32 s33, s33, 1280
    buffer_load_dwordx4 v[116:119], v5, s[12:15], s33 offen
    s_add_u32 s33, s33, 1280
    buffer_load_dwordx4 v[120:123], v5, s[12:15], s33 offen
    s_add_u32 s33, s33, 1280
    buffer_load_dwordx4 v[124:127], v5, s[12:15], s33 offen
    s_mov_b64 exec, s[30:31]
    s_cmp_lt_u32 s2, 128
    s_cbranch_scc0 L_cb_B
    v_lshrrev_b32 v6, 6, v0
    s_nop 0
    v_readfirstlane_b32 s28, v6
    s_cmp_eq_u32 s28, 0
    s_cbranch_scc0 L_cb_A1
    s_mul_i32 s29, s24, 128
    s_add_u32 s29, s29, 294912
    v_lshlrev_b32 v6, 3, v1
    v_mov_b32 v8, 0xff800000
    v_mov_b32 v9, 0
    v_cmp_gt_u32 vcc, 16, v1
    s_and_saveexec_b64 s[30:31], vcc
    buffer_load_dwordx2 v[8:9], v6, s[20:23], s29 offen
    s_waitcnt vmcnt(0)
    s_mov_b64 exec, s[30:31]
    v_mov_b32 v7, v8
    v_xor_b32 v6, 4, v30
    ds_bpermute_b32 v6, v6, v7
    s_waitcnt lgkmcnt(0)
    v_max_f32 v7, v7, v6
    v_xor_b32 v6, 8, v30
    ds_bpermute_b32 v6, v6, v7
    s_waitcnt lgkmcnt(0)
    v_max_f32 v7, v7, v6
    v_xor_b32 v6, 16, v30
    ds_bpermute_b32 v6, v6, v7
    s_waitcnt lgkmcnt(0)
    v_max_f32 v7, v7, v6
    v_xor_b32 v6, 32, v30
    ds_bpermute_b32 v6, v6, v7
    s_waitcnt lgkmcnt(0)
    v_max_f32 v7, v7, v6
    v_xor_b32 v6, 64, v30
    ds_bpermute_b32 v6, v6, v7
    s_waitcnt lgkmcnt(0)
    v_max_f32 v7, v7, v6
    v_xor_b32 v6, 128, v30
    ds_bpermute_b32 v6, v6, v7
    s_waitcnt lgkmcnt(0)
    v_max_f32 v7, v7, v6
    v_sub_f32 v8, v8, v7
    v_exp_f32 v8, v8
    s_nop 0
    v_mul_f32 v9, v8, v9
    v_xor_b32 v6, 4, v30
    ds_bpermute_b32 v6, v6, v9
    s_waitcnt lgkmcnt(0)
    v_add_f32 v9, v9, v6
    v_xor_b32 v6, 8, v30
    ds_bpermute_b32 v6, v6, v9
    s_waitcnt lgkmcnt(0)
    v_add_f32 v9, v9, v6
    v_xor_b32 v6, 16, v30
    ds_bpermute_b32 v6, v6, v9
    s_waitcnt lgkmcnt(0)
    v_add_f32 v9, v9, v6
    v_xor_b32 v6, 32, v30
    ds_bpermute_b32 v6, v6, v9
    s_waitcnt lgkmcnt(0)
    v_add_f32 v9, v9, v6
    v_xor_b32 v6, 64, v30
    ds_bpermute_b32 v6, v6, v9
    s_waitcnt lgkmcnt(0)
    v_add_f32 v9, v9, v6
    v_xor_b32 v6, 128, v30
    ds_bpermute_b32 v6, v6, v9
    s_waitcnt lgkmcnt(0)
    v_add_f32 v9, v9, v6
    v_rcp_f32 v9, v9
    s_nop 0
    v_mul_f32 v8, v8, v9
    ds_write_b32 v30, v8
    s_waitcnt lgkmcnt(0)
L_cb_A1:
    s_barrier
    v_cmp_gt_u32 vcc, 192, v0
    s_and_saveexec_b64 s[30:31], vcc
    s_cbranch_execz L_cb_A2
    v_mul_u32_u24 v6, 1366, v0
    v_lshrrev_b32 v6, 16, v6
    v_mul_u32_u24 v7, 48, v6
    v_sub_u32 v7, v0, v7
    s_mul_i32 s29, s24, 12288
    s_mul_i32 s32, s25, 192
    s_add_u32 s29, s29, s32
    s_add_u32 s29, s29, 360448
    v_mul_u32_u24 v8, 768, v6
    v_lshl_add_u32 v8, v7, 2, v8
    buffer_load_dword v32, v8, s[20:23], s29 offen
    s_add_u32 s33, s29, 3072
    buffer_load_dword v33, v8, s[20:23], s33 offen
    s_add_u32 s33, s33, 3072
    buffer_load_dword v34, v8, s[20:23], s33 offen
    s_add_u32 s33, s33, 3072
    buffer_load_dword v35, v8, s[20:23], s33 offen
    v_lshlrev_b32 v9, 2, v6
    ds_read_b32 v12, v9 offset:0
    ds_read_b32 v13, v9 offset:16
    ds_read_b32 v14, v9 offset:32
    ds_read_b32 v15, v9 offset:48
    s_waitcnt vmcnt(0) lgkmcnt(0)
    v_mul_f32 v10, v32, v12
    v_fmac_f32 v10, v33, v13
    v_fmac_f32 v10, v34, v14
    v_fmac_f32 v10, v35, v15
    v_lshlrev_b32 v11, 2, v0
    ds_write_b32 v11, v10 offset:256
    s_waitcnt lgkmcnt(0)
L_cb_A2:
    s_mov_b64 exec, s[30:31]
    s_barrier
    v_cmp_gt_u32 vcc, 48, v0
    s_and_saveexec_b64 s[30:31], vcc
    s_cbranch_execz L_cb_A3
    v_lshlrev_b32 v7, 2, v0
    ds_read_b32 v8, v7 offset:256
    ds_read_b32 v9, v7 offset:448
    ds_read_b32 v10, v7 offset:640
    ds_read_b32 v11, v7 offset:832
    s_waitcnt lgkmcnt(0)
    v_add_f32 v8, v8, v9
    v_add_f32 v10, v10, v11
    v_add_f32 v8, v8, v10
    v_cvt_pk_bf16_f32 v9, v8, v8
    v_lshlrev_b32 v8, 16, v9
    ds_write_b32 v7, v8 offset:1024
    s_waitcnt lgkmcnt(0)
L_cb_A3:
    s_mov_b64 exec, s[30:31]
    s_branch L_cb_gemv
L_cb_B:
    v_cmp_gt_u32 vcc, 48, v0
    s_and_saveexec_b64 s[30:31], vcc
    s_cbranch_execz L_cb_B1
    s_lshl_b32 s29, s26, 2
    v_lshlrev_b32 v7, 2, v0
    v_add_u32 v6, s29, v7
    s_mov_b32 s33, 196608
    buffer_load_dword v32, v6, s[20:23], s33 offen
    s_mov_b32 s33, 245760
    buffer_load_dword v40, v6, s[20:23], s33 offen
    s_mov_b32 s33, 202752
    buffer_load_dword v33, v6, s[20:23], s33 offen
    s_mov_b32 s33, 251904
    buffer_load_dword v41, v6, s[20:23], s33 offen
    s_mov_b32 s33, 208896
    buffer_load_dword v34, v6, s[20:23], s33 offen
    s_mov_b32 s33, 258048
    buffer_load_dword v42, v6, s[20:23], s33 offen
    s_mov_b32 s33, 215040
    buffer_load_dword v35, v6, s[20:23], s33 offen
    s_mov_b32 s33, 264192
    buffer_load_dword v43, v6, s[20:23], s33 offen
    s_mov_b32 s33, 221184
    buffer_load_dword v36, v6, s[20:23], s33 offen
    s_mov_b32 s33, 270336
    buffer_load_dword v44, v6, s[20:23], s33 offen
    s_mov_b32 s33, 227328
    buffer_load_dword v37, v6, s[20:23], s33 offen
    s_mov_b32 s33, 276480
    buffer_load_dword v45, v6, s[20:23], s33 offen
    s_mov_b32 s33, 233472
    buffer_load_dword v38, v6, s[20:23], s33 offen
    s_mov_b32 s33, 282624
    buffer_load_dword v46, v6, s[20:23], s33 offen
    s_mov_b32 s33, 239616
    buffer_load_dword v39, v6, s[20:23], s33 offen
    s_mov_b32 s33, 288768
    buffer_load_dword v47, v6, s[20:23], s33 offen
    s_waitcnt vmcnt(0)
    v_add_f32 v32, v32, v33
    v_add_f32 v40, v40, v41
    v_add_f32 v32, v32, v34
    v_add_f32 v40, v40, v42
    v_add_f32 v32, v32, v35
    v_add_f32 v40, v40, v43
    v_add_f32 v32, v32, v36
    v_add_f32 v40, v40, v44
    v_add_f32 v32, v32, v37
    v_add_f32 v40, v40, v45
    v_add_f32 v32, v32, v38
    v_add_f32 v40, v40, v46
    v_add_f32 v32, v32, v39
    v_add_f32 v40, v40, v47
    v_cvt_pk_bf16_f32 v9, v32, v32
    v_lshlrev_b32 v32, 16, v9
    v_cvt_pk_bf16_f32 v9, v40, v40
    v_lshlrev_b32 v40, 16, v9
    v_mul_f32 v8, 0x3fb8aa3b, v32
    v_sub_f32 v8, 0, v8
    v_exp_f32 v8, v8
    s_nop 0
    v_add_f32 v8, 1.0, v8
    v_rcp_f32 v8, v8
    s_nop 0
    v_mul_f32 v8, v32, v8
    v_cvt_pk_bf16_f32 v9, v8, v8
    v_lshlrev_b32 v8, 16, v9
    v_mul_f32 v8, v8, v40
    v_cvt_pk_bf16_f32 v9, v8, v8
    v_lshlrev_b32 v8, 16, v9
    ds_write_b32 v7, v8 offset:1024
    s_waitcnt lgkmcnt(0)
L_cb_B1:
    s_mov_b64 exec, s[30:31]
L_cb_gemv:
    s_barrier
    v_cmp_gt_u32 vcc, 240, v0
    s_and_saveexec_b64 s[30:31], vcc
    s_cbranch_execz L_cb_G1
    v_lshlrev_b32 v4, 6, v2
    ds_read_b128 v[32:35], v4 offset:1024
    ds_read_b128 v[36:39], v4 offset:1040
    ds_read_b128 v[40:43], v4 offset:1056
    ds_read_b128 v[44:47], v4 offset:1072
    v_mov_b32 v10, 0
    v_mov_b32 v11, 0
    v_mov_b32 v12, 0
    v_mov_b32 v13, 0
    v_mov_b32 v14, 0
    v_mov_b32 v15, 0
    v_mov_b32 v16, 0
    v_mov_b32 v17, 0
    s_waitcnt lgkmcnt(0)
    s_waitcnt vmcnt(15)
    v_lshlrev_b32 v6, 16, v64
    v_and_b32 v7, 0xffff0000, v64
    v_fmac_f32 v10, v32, v6
    v_fmac_f32 v11, v32, v7
    v_lshlrev_b32 v6, 16, v65
    v_and_b32 v7, 0xffff0000, v65
    v_fmac_f32 v12, v32, v6
    v_fmac_f32 v13, v32, v7
    v_lshlrev_b32 v6, 16, v66
    v_and_b32 v7, 0xffff0000, v66
    v_fmac_f32 v14, v32, v6
    v_fmac_f32 v15, v32, v7
    v_lshlrev_b32 v6, 16, v67
    v_and_b32 v7, 0xffff0000, v67
    v_fmac_f32 v16, v32, v6
    v_fmac_f32 v17, v32, v7
    s_waitcnt vmcnt(14)
    v_lshlrev_b32 v6, 16, v68
    v_and_b32 v7, 0xffff0000, v68
    v_fmac_f32 v10, v33, v6
    v_fmac_f32 v11, v33, v7
    v_lshlrev_b32 v6, 16, v69
    v_and_b32 v7, 0xffff0000, v69
    v_fmac_f32 v12, v33, v6
    v_fmac_f32 v13, v33, v7
    v_lshlrev_b32 v6, 16, v70
    v_and_b32 v7, 0xffff0000, v70
    v_fmac_f32 v14, v33, v6
    v_fmac_f32 v15, v33, v7
    v_lshlrev_b32 v6, 16, v71
    v_and_b32 v7, 0xffff0000, v71
    v_fmac_f32 v16, v33, v6
    v_fmac_f32 v17, v33, v7
    s_waitcnt vmcnt(13)
    v_lshlrev_b32 v6, 16, v72
    v_and_b32 v7, 0xffff0000, v72
    v_fmac_f32 v10, v34, v6
    v_fmac_f32 v11, v34, v7
    v_lshlrev_b32 v6, 16, v73
    v_and_b32 v7, 0xffff0000, v73
    v_fmac_f32 v12, v34, v6
    v_fmac_f32 v13, v34, v7
    v_lshlrev_b32 v6, 16, v74
    v_and_b32 v7, 0xffff0000, v74
    v_fmac_f32 v14, v34, v6
    v_fmac_f32 v15, v34, v7
    v_lshlrev_b32 v6, 16, v75
    v_and_b32 v7, 0xffff0000, v75
    v_fmac_f32 v16, v34, v6
    v_fmac_f32 v17, v34, v7
    s_waitcnt vmcnt(12)
    v_lshlrev_b32 v6, 16, v76
    v_and_b32 v7, 0xffff0000, v76
    v_fmac_f32 v10, v35, v6
    v_fmac_f32 v11, v35, v7
    v_lshlrev_b32 v6, 16, v77
    v_and_b32 v7, 0xffff0000, v77
    v_fmac_f32 v12, v35, v6
    v_fmac_f32 v13, v35, v7
    v_lshlrev_b32 v6, 16, v78
    v_and_b32 v7, 0xffff0000, v78
    v_fmac_f32 v14, v35, v6
    v_fmac_f32 v15, v35, v7
    v_lshlrev_b32 v6, 16, v79
    v_and_b32 v7, 0xffff0000, v79
    v_fmac_f32 v16, v35, v6
    v_fmac_f32 v17, v35, v7
    s_waitcnt vmcnt(11)
    v_lshlrev_b32 v6, 16, v80
    v_and_b32 v7, 0xffff0000, v80
    v_fmac_f32 v10, v36, v6
    v_fmac_f32 v11, v36, v7
    v_lshlrev_b32 v6, 16, v81
    v_and_b32 v7, 0xffff0000, v81
    v_fmac_f32 v12, v36, v6
    v_fmac_f32 v13, v36, v7
    v_lshlrev_b32 v6, 16, v82
    v_and_b32 v7, 0xffff0000, v82
    v_fmac_f32 v14, v36, v6
    v_fmac_f32 v15, v36, v7
    v_lshlrev_b32 v6, 16, v83
    v_and_b32 v7, 0xffff0000, v83
    v_fmac_f32 v16, v36, v6
    v_fmac_f32 v17, v36, v7
    s_waitcnt vmcnt(10)
    v_lshlrev_b32 v6, 16, v84
    v_and_b32 v7, 0xffff0000, v84
    v_fmac_f32 v10, v37, v6
    v_fmac_f32 v11, v37, v7
    v_lshlrev_b32 v6, 16, v85
    v_and_b32 v7, 0xffff0000, v85
    v_fmac_f32 v12, v37, v6
    v_fmac_f32 v13, v37, v7
    v_lshlrev_b32 v6, 16, v86
    v_and_b32 v7, 0xffff0000, v86
    v_fmac_f32 v14, v37, v6
    v_fmac_f32 v15, v37, v7
    v_lshlrev_b32 v6, 16, v87
    v_and_b32 v7, 0xffff0000, v87
    v_fmac_f32 v16, v37, v6
    v_fmac_f32 v17, v37, v7
    s_waitcnt vmcnt(9)
    v_lshlrev_b32 v6, 16, v88
    v_and_b32 v7, 0xffff0000, v88
    v_fmac_f32 v10, v38, v6
    v_fmac_f32 v11, v38, v7
    v_lshlrev_b32 v6, 16, v89
    v_and_b32 v7, 0xffff0000, v89
    v_fmac_f32 v12, v38, v6
    v_fmac_f32 v13, v38, v7
    v_lshlrev_b32 v6, 16, v90
    v_and_b32 v7, 0xffff0000, v90
    v_fmac_f32 v14, v38, v6
    v_fmac_f32 v15, v38, v7
    v_lshlrev_b32 v6, 16, v91
    v_and_b32 v7, 0xffff0000, v91
    v_fmac_f32 v16, v38, v6
    v_fmac_f32 v17, v38, v7
    s_waitcnt vmcnt(8)
    v_lshlrev_b32 v6, 16, v92
    v_and_b32 v7, 0xffff0000, v92
    v_fmac_f32 v10, v39, v6
    v_fmac_f32 v11, v39, v7
    v_lshlrev_b32 v6, 16, v93
    v_and_b32 v7, 0xffff0000, v93
    v_fmac_f32 v12, v39, v6
    v_fmac_f32 v13, v39, v7
    v_lshlrev_b32 v6, 16, v94
    v_and_b32 v7, 0xffff0000, v94
    v_fmac_f32 v14, v39, v6
    v_fmac_f32 v15, v39, v7
    v_lshlrev_b32 v6, 16, v95
    v_and_b32 v7, 0xffff0000, v95
    v_fmac_f32 v16, v39, v6
    v_fmac_f32 v17, v39, v7
    s_waitcnt vmcnt(7)
    v_lshlrev_b32 v6, 16, v96
    v_and_b32 v7, 0xffff0000, v96
    v_fmac_f32 v10, v40, v6
    v_fmac_f32 v11, v40, v7
    v_lshlrev_b32 v6, 16, v97
    v_and_b32 v7, 0xffff0000, v97
    v_fmac_f32 v12, v40, v6
    v_fmac_f32 v13, v40, v7
    v_lshlrev_b32 v6, 16, v98
    v_and_b32 v7, 0xffff0000, v98
    v_fmac_f32 v14, v40, v6
    v_fmac_f32 v15, v40, v7
    v_lshlrev_b32 v6, 16, v99
    v_and_b32 v7, 0xffff0000, v99
    v_fmac_f32 v16, v40, v6
    v_fmac_f32 v17, v40, v7
    s_waitcnt vmcnt(6)
    v_lshlrev_b32 v6, 16, v100
    v_and_b32 v7, 0xffff0000, v100
    v_fmac_f32 v10, v41, v6
    v_fmac_f32 v11, v41, v7
    v_lshlrev_b32 v6, 16, v101
    v_and_b32 v7, 0xffff0000, v101
    v_fmac_f32 v12, v41, v6
    v_fmac_f32 v13, v41, v7
    v_lshlrev_b32 v6, 16, v102
    v_and_b32 v7, 0xffff0000, v102
    v_fmac_f32 v14, v41, v6
    v_fmac_f32 v15, v41, v7
    v_lshlrev_b32 v6, 16, v103
    v_and_b32 v7, 0xffff0000, v103
    v_fmac_f32 v16, v41, v6
    v_fmac_f32 v17, v41, v7
    s_waitcnt vmcnt(5)
    v_lshlrev_b32 v6, 16, v104
    v_and_b32 v7, 0xffff0000, v104
    v_fmac_f32 v10, v42, v6
    v_fmac_f32 v11, v42, v7
    v_lshlrev_b32 v6, 16, v105
    v_and_b32 v7, 0xffff0000, v105
    v_fmac_f32 v12, v42, v6
    v_fmac_f32 v13, v42, v7
    v_lshlrev_b32 v6, 16, v106
    v_and_b32 v7, 0xffff0000, v106
    v_fmac_f32 v14, v42, v6
    v_fmac_f32 v15, v42, v7
    v_lshlrev_b32 v6, 16, v107
    v_and_b32 v7, 0xffff0000, v107
    v_fmac_f32 v16, v42, v6
    v_fmac_f32 v17, v42, v7
    s_waitcnt vmcnt(4)
    v_lshlrev_b32 v6, 16, v108
    v_and_b32 v7, 0xffff0000, v108
    v_fmac_f32 v10, v43, v6
    v_fmac_f32 v11, v43, v7
    v_lshlrev_b32 v6, 16, v109
    v_and_b32 v7, 0xffff0000, v109
    v_fmac_f32 v12, v43, v6
    v_fmac_f32 v13, v43, v7
    v_lshlrev_b32 v6, 16, v110
    v_and_b32 v7, 0xffff0000, v110
    v_fmac_f32 v14, v43, v6
    v_fmac_f32 v15, v43, v7
    v_lshlrev_b32 v6, 16, v111
    v_and_b32 v7, 0xffff0000, v111
    v_fmac_f32 v16, v43, v6
    v_fmac_f32 v17, v43, v7
    s_waitcnt vmcnt(3)
    v_lshlrev_b32 v6, 16, v112
    v_and_b32 v7, 0xffff0000, v112
    v_fmac_f32 v10, v44, v6
    v_fmac_f32 v11, v44, v7
    v_lshlrev_b32 v6, 16, v113
    v_and_b32 v7, 0xffff0000, v113
    v_fmac_f32 v12, v44, v6
    v_fmac_f32 v13, v44, v7
    v_lshlrev_b32 v6, 16, v114
    v_and_b32 v7, 0xffff0000, v114
    v_fmac_f32 v14, v44, v6
    v_fmac_f32 v15, v44, v7
    v_lshlrev_b32 v6, 16, v115
    v_and_b32 v7, 0xffff0000, v115
    v_fmac_f32 v16, v44, v6
    v_fmac_f32 v17, v44, v7
    s_waitcnt vmcnt(2)
    v_lshlrev_b32 v6, 16, v116
    v_and_b32 v7, 0xffff0000, v116
    v_fmac_f32 v10, v45, v6
    v_fmac_f32 v11, v45, v7
    v_lshlrev_b32 v6, 16, v117
    v_and_b32 v7, 0xffff0000, v117
    v_fmac_f32 v12, v45, v6
    v_fmac_f32 v13, v45, v7
    v_lshlrev_b32 v6, 16, v118
    v_and_b32 v7, 0xffff0000, v118
    v_fmac_f32 v14, v45, v6
    v_fmac_f32 v15, v45, v7
    v_lshlrev_b32 v6, 16, v119
    v_and_b32 v7, 0xffff0000, v119
    v_fmac_f32 v16, v45, v6
    v_fmac_f32 v17, v45, v7
    s_waitcnt vmcnt(1)
    v_lshlrev_b32 v6, 16, v120
    v_and_b32 v7, 0xffff0000, v120
    v_fmac_f32 v10, v46, v6
    v_fmac_f32 v11, v46, v7
    v_lshlrev_b32 v6, 16, v121
    v_and_b32 v7, 0xffff0000, v121
    v_fmac_f32 v12, v46, v6
    v_fmac_f32 v13, v46, v7
    v_lshlrev_b32 v6, 16, v122
    v_and_b32 v7, 0xffff0000, v122
    v_fmac_f32 v14, v46, v6
    v_fmac_f32 v15, v46, v7
    v_lshlrev_b32 v6, 16, v123
    v_and_b32 v7, 0xffff0000, v123
    v_fmac_f32 v16, v46, v6
    v_fmac_f32 v17, v46, v7
    s_waitcnt vmcnt(0)
    v_lshlrev_b32 v6, 16, v124
    v_and_b32 v7, 0xffff0000, v124
    v_fmac_f32 v10, v47, v6
    v_fmac_f32 v11, v47, v7
    v_lshlrev_b32 v6, 16, v125
    v_and_b32 v7, 0xffff0000, v125
    v_fmac_f32 v12, v47, v6
    v_fmac_f32 v13, v47, v7
    v_lshlrev_b32 v6, 16, v126
    v_and_b32 v7, 0xffff0000, v126
    v_fmac_f32 v14, v47, v6
    v_fmac_f32 v15, v47, v7
    v_lshlrev_b32 v6, 16, v127
    v_and_b32 v7, 0xffff0000, v127
    v_fmac_f32 v16, v47, v6
    v_fmac_f32 v17, v47, v7
    v_mul_u32_u24 v6, 2560, v2
    v_lshl_add_u32 v6, v3, 5, v6
    ds_write_b128 v6, v[10:13] offset:2048
    ds_write_b128 v6, v[14:17] offset:2064
    s_waitcnt lgkmcnt(0)
L_cb_G1:
    s_mov_b64 exec, s[30:31]
    s_barrier
    v_cmp_gt_u32 vcc, 160, v0
    s_and_saveexec_b64 s[30:31], vcc
    s_cbranch_execz L_cb_end
    v_lshlrev_b32 v6, 4, v0
    ds_read_b128 v[8:11], v6 offset:2048
    ds_read_b128 v[12:15], v6 offset:4608
    ds_read_b128 v[16:19], v6 offset:7168
    s_waitcnt lgkmcnt(0)
    v_add_f32 v8, v8, v12
    v_add_f32 v8, v8, v16
    v_add_f32 v9, v9, v13
    v_add_f32 v9, v9, v17
    v_add_f32 v10, v10, v14
    v_add_f32 v10, v10, v18
    v_add_f32 v11, v11, v15
    v_add_f32 v11, v11, v19
    s_mul_i32 s33, s2, 2560
    s_add_u32 s33, s33, 4554752
    buffer_store_dwordx4 v[8:11], v6, s[20:23], s33 offen
L_cb_end:
    s_endpgm
.globl final_kernel
.p2align 8
.type final_kernel,@function
final_kernel:
    s_cmp_ge_u32 s2, 10
    s_cbranch_scc1 L_fn_end
    s_load_dwordx2 s[4:5], s[0:1], 0
    s_load_dwordx2 s[6:7], s[0:1], 72
    s_load_dwordx2 s[8:9], s[0:1], 88
    s_waitcnt lgkmcnt(0)
    s_mov_b32 s12, s4
    s_mov_b32 s13, s5
    s_mov_b32 s14, 1280
    s_mov_b32 s15, 0x00020000
    s_mov_b32 s16, s6
    s_mov_b32 s17, s7
    s_mov_b32 s18, 1280
    s_mov_b32 s19, 0x00020000
    s_mov_b32 s20, s8
    s_mov_b32 s21, s9
    s_mov_b32 s22, 4964352
    s_mov_b32 s23, 0x00020000
    v_and_b32 v1, 63, v0
    v_lshrrev_b32 v2, 6, v0
    s_lshl_b32 s24, s2, 8
    v_lshlrev_b32 v3, 2, v1
    v_add_u32 v3, s24, v3
    v_mul_u32_u24 v4, 81920, v2
    v_add_u32 v4, v4, v3
    s_mov_b32 s25, 4554752
    buffer_load_dword v10, v4, s[20:23], s25 offen
    s_add_u32 s25, s25, 2560
    buffer_load_dword v11, v4, s[20:23], s25 offen
    s_add_u32 s25, s25, 2560
    buffer_load_dword v12, v4, s[20:23], s25 offen
    s_add_u32 s25, s25, 2560
    buffer_load_dword v13, v4, s[20:23], s25 offen
    s_add_u32 s25, s25, 2560
    buffer_load_dword v14, v4, s[20:23], s25 offen
    s_add_u32 s25, s25, 2560
    buffer_load_dword v15, v4, s[20:23], s25 offen
    s_add_u32 s25, s25, 2560
    buffer_load_dword v16, v4, s[20:23], s25 offen
    s_add_u32 s25, s25, 2560
    buffer_load_dword v17, v4, s[20:23], s25 offen
    s_add_u32 s25, s25, 2560
    buffer_load_dword v18, v4, s[20:23], s25 offen
    s_add_u32 s25, s25, 2560
    buffer_load_dword v19, v4, s[20:23], s25 offen
    s_add_u32 s25, s25, 2560
    buffer_load_dword v20, v4, s[20:23], s25 offen
    s_add_u32 s25, s25, 2560
    buffer_load_dword v21, v4, s[20:23], s25 offen
    s_add_u32 s25, s25, 2560
    buffer_load_dword v22, v4, s[20:23], s25 offen
    s_add_u32 s25, s25, 2560
    buffer_load_dword v23, v4, s[20:23], s25 offen
    s_add_u32 s25, s25, 2560
    buffer_load_dword v24, v4, s[20:23], s25 offen
    s_add_u32 s25, s25, 2560
    buffer_load_dword v25, v4, s[20:23], s25 offen
    s_add_u32 s25, s25, 2560
    buffer_load_dword v26, v4, s[20:23], s25 offen
    s_add_u32 s25, s25, 2560
    buffer_load_dword v27, v4, s[20:23], s25 offen
    s_add_u32 s25, s25, 2560
    buffer_load_dword v28, v4, s[20:23], s25 offen
    s_add_u32 s25, s25, 2560
    buffer_load_dword v29, v4, s[20:23], s25 offen
    s_add_u32 s25, s25, 2560
    buffer_load_dword v30, v4, s[20:23], s25 offen
    s_add_u32 s25, s25, 2560
    buffer_load_dword v31, v4, s[20:23], s25 offen
    s_add_u32 s25, s25, 2560
    buffer_load_dword v32, v4, s[20:23], s25 offen
    s_add_u32 s25, s25, 2560
    buffer_load_dword v33, v4, s[20:23], s25 offen
    s_add_u32 s25, s25, 2560
    buffer_load_dword v34, v4, s[20:23], s25 offen
    s_add_u32 s25, s25, 2560
    buffer_load_dword v35, v4, s[20:23], s25 offen
    s_add_u32 s25, s25, 2560
    buffer_load_dword v36, v4, s[20:23], s25 offen
    s_add_u32 s25, s25, 2560
    buffer_load_dword v37, v4, s[20:23], s25 offen
    s_add_u32 s25, s25, 2560
    buffer_load_dword v38, v4, s[20:23], s25 offen
    s_add_u32 s25, s25, 2560
    buffer_load_dword v39, v4, s[20:23], s25 offen
    s_add_u32 s25, s25, 2560
    buffer_load_dword v40, v4, s[20:23], s25 offen
    s_add_u32 s25, s25, 2560
    buffer_load_dword v41, v4, s[20:23], s25 offen
    s_add_u32 s25, s25, 2560
    v_mul_u32_u24 v5, 20480, v2
    v_add_u32 v5, v5, v3
    s_mov_b32 s25, 4882432
    buffer_load_dword v44, v5, s[20:23], s25 offen
    s_add_u32 s25, s25, 2560
    buffer_load_dword v45, v5, s[20:23], s25 offen
    s_add_u32 s25, s25, 2560
    buffer_load_dword v46, v5, s[20:23], s25 offen
    s_add_u32 s25, s25, 2560
    buffer_load_dword v47, v5, s[20:23], s25 offen
    s_add_u32 s25, s25, 2560
    buffer_load_dword v48, v5, s[20:23], s25 offen
    s_add_u32 s25, s25, 2560
    buffer_load_dword v49, v5, s[20:23], s25 offen
    s_add_u32 s25, s25, 2560
    buffer_load_dword v50, v5, s[20:23], s25 offen
    s_add_u32 s25, s25, 2560
    buffer_load_dword v51, v5, s[20:23], s25 offen
    s_add_u32 s25, s25, 2560
    s_waitcnt vmcnt(0)
    v_add_f32 v10, v10, v11
    v_add_f32 v10, v10, v12
    v_add_f32 v10, v10, v13
    v_add_f32 v10, v10, v14
    v_add_f32 v10, v10, v15
    v_add_f32 v10, v10, v16
    v_add_f32 v10, v10, v17
    v_add_f32 v10, v10, v18
    v_add_f32 v10, v10, v19
    v_add_f32 v10, v10, v20
    v_add_f32 v10, v10, v21
    v_add_f32 v10, v10, v22
    v_add_f32 v10, v10, v23
    v_add_f32 v10, v10, v24
    v_add_f32 v10, v10, v25
    v_add_f32 v10, v10, v26
    v_add_f32 v10, v10, v27
    v_add_f32 v10, v10, v28
    v_add_f32 v10, v10, v29
    v_add_f32 v10, v10, v30
    v_add_f32 v10, v10, v31
    v_add_f32 v10, v10, v32
    v_add_f32 v10, v10, v33
    v_add_f32 v10, v10, v34
    v_add_f32 v10, v10, v35
    v_add_f32 v10, v10, v36
    v_add_f32 v10, v10, v37
    v_add_f32 v10, v10, v38
    v_add_f32 v10, v10, v39
    v_add_f32 v10, v10, v40
    v_add_f32 v10, v10, v41
    v_add_f32 v44, v44, v45
    v_add_f32 v44, v44, v46
    v_add_f32 v44, v44, v47
    v_add_f32 v44, v44, v48
    v_add_f32 v44, v44, v49
    v_add_f32 v44, v44, v50
    v_add_f32 v44, v44, v51
    v_lshlrev_b32 v6, 3, v0
    v_mov_b32 v11, v44
    ds_write_b64 v6, v[10:11]
    s_waitcnt lgkmcnt(0)
    s_barrier
    v_cmp_gt_u32 vcc, 64, v0
    s_and_saveexec_b64 s[30:31], vcc
    s_cbranch_execz L_fn_end
    ds_read_b64 v[12:13], v6 offset:0
    ds_read_b64 v[14:15], v6 offset:512
    ds_read_b64 v[16:17], v6 offset:1024
    ds_read_b64 v[18:19], v6 offset:1536
    v_lshlrev_b32 v7, 1, v1
    s_lshl_b32 s24, s2, 7
    v_add_u32 v7, s24, v7
    buffer_load_ushort v8, v7, s[12:15], 0 offen
    s_waitcnt vmcnt(0) lgkmcnt(0)
    v_add_f32 v12, v12, v14
    v_add_f32 v16, v16, v18
    v_add_f32 v12, v12, v16
    v_add_f32 v13, v13, v15
    v_add_f32 v17, v17, v19
    v_add_f32 v13, v13, v17
    v_cvt_pk_bf16_f32 v9, v12, v12
    v_lshlrev_b32 v12, 16, v9
    v_cvt_pk_bf16_f32 v9, v13, v13
    v_lshlrev_b32 v13, 16, v9
    v_mul_f32 v14, 0x3fb8aa3b, v13
    v_sub_f32 v14, 0, v14
    v_exp_f32 v14, v14
    s_nop 0
    v_add_f32 v14, 1.0, v14
    v_rcp_f32 v14, v14
    s_nop 0
    v_mul_f32 v14, v13, v14
    v_cvt_pk_bf16_f32 v9, v14, v14
    v_lshlrev_b32 v14, 16, v9
    v_mul_f32 v14, v12, v14
    v_cvt_pk_bf16_f32 v9, v14, v14
    v_lshlrev_b32 v14, 16, v9
    v_lshlrev_b32 v8, 16, v8
    v_add_f32 v14, v8, v14
    v_cvt_pk_bf16_f32 v14, v14, v14
    buffer_store_short v14, v7, s[16:19], 0 offen
L_fn_end:
    s_endpgm
.section .rodata,"a"
.p2align 6
.amdhsa_kernel proj1_kernel
  .amdhsa_next_free_vgpr 152
  .amdhsa_next_free_sgpr 96
  .amdhsa_accum_offset 152
  .amdhsa_group_segment_fixed_size 0
  .amdhsa_kernarg_size 96
  .amdhsa_user_sgpr_count 2
  .amdhsa_user_sgpr_kernarg_segment_ptr 1
  .amdhsa_system_sgpr_workgroup_id_x 1
.end_amdhsa_kernel
.p2align 6
.amdhsa_kernel attn_kernel
  .amdhsa_next_free_vgpr 256
  .amdhsa_next_free_sgpr 96
  .amdhsa_accum_offset 256
  .amdhsa_group_segment_fixed_size 0
  .amdhsa_kernarg_size 96
  .amdhsa_user_sgpr_count 2
  .amdhsa_user_sgpr_kernarg_segment_ptr 1
  .amdhsa_system_sgpr_workgroup_id_x 1
.end_amdhsa_kernel
.p2align 6
.amdhsa_kernel comb_kernel
  .amdhsa_next_free_vgpr 128
  .amdhsa_next_free_sgpr 96
  .amdhsa_accum_offset 128
  .amdhsa_group_segment_fixed_size 0
  .amdhsa_kernarg_size 96
  .amdhsa_user_sgpr_count 2
  .amdhsa_user_sgpr_kernarg_segment_ptr 1
  .amdhsa_system_sgpr_workgroup_id_x 1
.end_amdhsa_kernel
.p2align 6
.amdhsa_kernel final_kernel
  .amdhsa_next_free_vgpr 56
  .amdhsa_next_free_sgpr 96
  .amdhsa_accum_offset 56
  .amdhsa_group_segment_fixed_size 0
  .amdhsa_kernarg_size 96
  .amdhsa_user_sgpr_count 2
  .amdhsa_user_sgpr_kernarg_segment_ptr 1
  .amdhsa_system_sgpr_workgroup_id_x 1
.end_amdhsa_kernel
```
